```python
import torch

def _softmax(x, axis=-1):
    return torch.softmax(x, dim=axis)
def _gelu(x):
    return torch.nn.functional.gelu(x, approximate="tanh")
def _silu(x):
    return torch.nn.functional.silu(x)
def _sigmoid(x):
    return torch.sigmoid(x)
def _layernorm(x, axis=-1, eps=1e-5):
    m = x.mean(dim=axis, keepdim=True)
    v = x.var(dim=axis, keepdim=True, unbiased=False)
    return (x - m) / torch.sqrt(v + eps)
def _scatter_add(tgt, idx, src, axis=0):
    return tgt.clone().index_add_(axis, idx, src)
def _segment_sum(src, seg, n):
    out = torch.zeros((n,) + src.shape[1:], dtype=src.dtype)
    return out.index_add_(0, seg, src)
def _pad(x, pw):
    flat = tuple(v for pair in reversed(pw) for v in pair)
    return torch.nn.functional.pad(x, flat)

kernel_name = 'interleave_layers__linear_kernel_hedgehog__glu_gated_swiglu__prompt'

def setup_inputs():

    _w = (lambda a: (lambda t: t.to(torch.bfloat16) if t.is_floating_point() else t)(torch.as_tensor(a)))
    def _A_setup():
        B, S, D, H = 1, 2048, 512, 32
        Dh = D // H
        return {
            "x": _w((lambda *s: torch.randn(*s, dtype=torch.bfloat16) * 0.05)(B, S, D)),
            "wqkv": _w((lambda *s: torch.randn(*s, dtype=torch.bfloat16) * 0.4)(D, 3 * D)),
            "w_phi": _w((lambda *s: torch.randn(*s, dtype=torch.bfloat16) * 0.4)(H, Dh, Dh) * (Dh ** -0.5)),
            "wo": _w((lambda *s: torch.randn(*s, dtype=torch.bfloat16) * 0.05)(D, D)),
        }
    _A_in = _A_setup()

    def _B_setup():
        B, S, D, F = 1, 2048, 512, 1792
        return {
            "x": _w((lambda *s: torch.randn(*s, dtype=torch.bfloat16) * 0.05)(B, S, D)),
            "w1": _w((lambda *s: torch.randn(*s, dtype=torch.bfloat16) * 0.8)(D, F) * (2.0 / D) ** 0.5),
            "w3": _w((lambda *s: torch.randn(*s, dtype=torch.bfloat16) * 0.8)(D, F) * (2.0 / D) ** 0.5),
            "w2": _w((lambda *s: torch.randn(*s, dtype=torch.bfloat16) * 0.8)(F, D) * (2.0 / F) ** 0.5),
        }
    _B_in = _B_setup()

    return {
        "A_x": _A_in["x"],
        "A_wqkv": _A_in["wqkv"],
        "A_w_phi": _A_in["w_phi"],
        "A_wo": _A_in["wo"],
        "B_x": _B_in["x"],
        "B_w1": _B_in["w1"],
        "B_w3": _B_in["w3"],
        "B_w2": _B_in["w2"],
    }

def reference(A_x, A_wqkv, A_w_phi, A_wo, B_x, B_w1, B_w3, B_w2):
    def _A_ref(x, wqkv, w_phi, wo):
        B, S, D = x.shape
        H = 32; Dh = D // H
        qkv = (lambda x, *d: x.permute(*d))((x @ wqkv).reshape(B, S, 3, H, Dh), 2, 0, 3, 1, 4)
        q, k, v = qkv[0], qkv[1], qkv[2]
        pq = torch.einsum("bhsd,hdf->bhsf", q, w_phi)
        pk = torch.einsum("bhsd,hdf->bhsf", k, w_phi)
        phi_q = torch.concatenate([_softmax(pq, axis=-1), _softmax(-pq, axis=-1)], axis=-1)
        phi_k = torch.concatenate([_softmax(pk, axis=-1), _softmax(-pk, axis=-1)], axis=-1)
        kv = torch.einsum("bhsf,bhsd->bhfd", phi_k, v)
        z  = torch.einsum("bhsf->bhf", phi_k)
        num = torch.einsum("bhqf,bhfd->bhqd", phi_q, kv)
        den = torch.einsum("bhqf,bhf->bhq", phi_q, z)[..., None] + 1e-6
        o = num / den
        return (lambda x, *d: x.permute(*d))(o, 0, 2, 1, 3).reshape(B, S, D) @ wo

    def _B_ref(x, w1, w3, w2):
        gate = torch.einsum("bsd,df->bsf", x, w1)
        up = torch.einsum("bsd,df->bsf", x, w3)
        h = _silu(gate) * up
        out = torch.einsum("bsf,fd->bsd", h, w2)
        return out

    x = A_x
    x = x + _A_ref(_layernorm(x, axis=-1), A_wqkv, A_w_phi, A_wo)
    x = x + _B_ref(_layernorm(x, axis=-1), B_w1, B_w3, B_w2)
    x = x + _A_ref(_layernorm(x, axis=-1), A_wqkv, A_w_phi, A_wo)
    x = x + _B_ref(_layernorm(x, axis=-1), B_w1, B_w3, B_w2)
    return x
```

```asm
; @launch grid=(256,1,1) block=(256,1,1) lds=163840
.amdgcn_target "amdgcn-amd-amdhsa--gfx950"
.text
.globl interleave_layers__linear_kernel_hedgehog__glu_gated_swiglu__prompt_kernel
.p2align 8
.type interleave_layers__linear_kernel_hedgehog__glu_gated_swiglu__prompt_kernel,@function
interleave_layers__linear_kernel_hedgehog__glu_gated_swiglu__prompt_kernel:
  s_cmp_ge_u32 s2, 256
  s_cbranch_scc1 L_end
  s_load_dwordx16 s[40:55], s[0:1], 0
  s_load_dwordx4 s[56:59], s[0:1], 64
  s_load_dwordx2 s[60:61], s[0:1], 80
  v_and_b32 v1, 63, v0
  v_lshrrev_b32 v12, 6, v0
  v_lshlrev_b32 v2, 4, v1
  v_readfirstlane_b32 s12, v12
  v_add_u32 v3, 0x10000, v2
  s_mov_b32 s13, 0
  v_mov_b32 v134, 0
  v_mov_b32 v135, 0
  v_mov_b32 v214, 0
  s_waitcnt lgkmcnt(0)
  s_mov_b32 s4, s60
  s_mov_b32 s5, s61
  s_mov_b32 s6, 0x10000000
  s_mov_b32 s7, 0x20000
  s_cmp_eq_u32 s12, 1
  s_cbranch_scc1 L_pw1
  s_cmp_eq_u32 s12, 2
  s_cbranch_scc1 L_pw2
  s_cmp_eq_u32 s12, 3
  s_cbranch_scc1 L_pw3
  s_cmp_lg_u32 s12, 0
  s_cbranch_scc1 L_ua_s2
  s_cmp_ge_u32 s2, 192
  s_cbranch_scc1 L_ua_wo
  s_mov_b32 s8, s42
  s_mov_b32 s9, s43
  s_mov_b32 s10, 0x180000
  s_mov_b32 s11, 0x20000
  s_lshr_b32 s30, s2, 3
  s_and_b32 s31, s2, 7
  s_mov_b32 s21, 3072
  s_mul_i32 s22, s31, 196608
  s_lshl_b32 s32, s30, 7
  s_add_u32 s22, s22, s32
  s_lshr_b32 s32, s30, 3
  s_add_u32 s33, s32, 2
  s_cmp_ge_u32 s33, 3
  s_cselect_b32 s35, 3, 0
  s_sub_u32 s33, s33, s35
  s_lshl_b32 s34, s30, 1
  s_and_b32 s34, s34, 15
  s_mul_i32 s34, s34, 3
  s_add_u32 s34, s34, s33
  s_mul_i32 s34, s34, 33792
  s_add_u32 s34, s34, 1048576
  s_mov_b32 s25, 101376
  s_mov_b32 s27, 0
  s_branch L_ua_cs
L_ua_wo:
  s_mov_b32 s8, s46
  s_mov_b32 s9, s47
  s_mov_b32 s10, 0x80000
  s_mov_b32 s11, 0x20000
  s_sub_u32 s20, s2, 192
  s_lshr_b32 s30, s20, 3
  s_and_b32 s31, s20, 7
  s_mov_b32 s21, 1024
  s_lshl_b32 s22, s31, 16
  s_lshl_b32 s32, s30, 7
  s_add_u32 s22, s22, s32
  s_lshl_b32 s23, s30, 16
  s_lshl_b32 s32, s31, 13
  s_add_u32 s23, s23, s32
  s_add_u32 s23, s23, 7340032
  s_mov_b32 s24, 2048
  s_mov_b32 s25, 1024
  s_mov_b32 s26, 4
  s_mov_b32 s27, 0
  s_mov_b32 s28, 0
  s_mov_b32 s29, 0
  s_branch L_ua_pdone
L_ua_s2:
  s_sub_u32 s20, s12, 1
  s_lshl_b32 s20, s20, 8
  s_add_u32 s20, s20, s2
  s_cmp_ge_u32 s20, 448
  s_cbranch_scc1 L_ua_w2
  s_cmp_ge_u32 s20, 224
  s_cbranch_scc1 L_ua_w3
  s_mov_b32 s8, s50
  s_mov_b32 s9, s51
  s_mov_b32 s10, 0x1c0000
  s_mov_b32 s11, 0x20000
  s_mov_b32 s27, 1
  s_branch L_ua_w13
L_ua_w3:
  s_mov_b32 s8, s52
  s_mov_b32 s9, s53
  s_mov_b32 s10, 0x1c0000
  s_mov_b32 s11, 0x20000
  s_sub_u32 s20, s20, 224
  s_mov_b32 s27, 2
L_ua_w13:
  s_lshr_b32 s30, s20, 3
  s_and_b32 s31, s20, 7
  s_mov_b32 s21, 3584
  s_mul_i32 s22, s31, 229376
  s_lshl_b32 s32, s30, 7
  s_add_u32 s22, s22, s32
  s_mul_i32 s34, s30, 135168
  s_add_u32 s34, s34, 3145728
  s_mov_b32 s25, 67584
L_ua_cs:
  s_lshl_b32 s35, s31, 12
  s_add_u32 s23, s34, s35
  s_mov_b32 s24, 1024
  s_mov_b32 s26, 4
  s_mov_b32 s28, 1
  s_lshr_b32 s35, s31, 2
  s_lshl_b32 s35, s35, 9
  s_add_u32 s29, s34, s35
  s_and_b32 s35, s31, 3
  s_lshl_b32 s35, s35, 2
  s_add_u32 s29, s29, s35
  s_add_u32 s29, s29, 32768
  s_branch L_ua_pdone
L_ua_w2:
  s_mov_b32 s8, s54
  s_mov_b32 s9, s55
  s_mov_b32 s10, 0x1c0000
  s_mov_b32 s11, 0x20000
  s_sub_u32 s20, s20, 448
  s_lshr_b32 s30, s20, 4
  s_bfe_u32 s31, s20, 0x30001
  s_and_b32 s33, s20, 1
  s_mov_b32 s21, 1024
  s_mul_i32 s22, s30, 114688
  s_lshl_b32 s32, s33, 16
  s_add_u32 s22, s22, s32
  s_lshl_b32 s32, s31, 7
  s_add_u32 s22, s22, s32
  s_mul_i32 s23, s31, 229376
  s_lshr_b32 s32, s30, 2
  s_mul_i32 s32, s32, 57344
  s_add_u32 s23, s23, s32
  s_and_b32 s32, s30, 3
  s_lshl_b32 s32, s32, 11
  s_add_u32 s23, s23, s32
  s_lshl_b32 s32, s33, 15
  s_add_u32 s23, s23, s32
  s_add_u32 s23, s23, 8388608
  s_mov_b32 s24, 8192
  s_mov_b32 s25, 1024
  s_sub_u32 s26, 4, s33
  s_mov_b32 s27, 0
  s_mov_b32 s28, 0
  s_mov_b32 s29, 0
  s_cmp_lt_u32 s20, 256
  s_cselect_b32 s26, s26, 0
L_ua_pdone:
  s_mov_b32 s70, 131072
  v_lshrrev_b32 v23, 3, v1
  v_mul_lo_u32 v23, v23, s21
  v_and_b32 v24, 7, v1
  v_lshl_add_u32 v23, v24, 4, v23
  s_lshl_b32 s37, s21, 3
  s_mov_b32 s39, s22
  s_add_u32 m0, s70, 0
  s_nop 0
  buffer_load_dwordx4 v23, s[8:11], s39 offen lds
  s_add_u32 s39, s39, s37
  s_add_u32 m0, s70, 1024
  s_nop 0
  buffer_load_dwordx4 v23, s[8:11], s39 offen lds
  s_add_u32 s39, s39, s37
  s_add_u32 m0, s70, 2048
  s_nop 0
  buffer_load_dwordx4 v23, s[8:11], s39 offen lds
  s_add_u32 s39, s39, s37
  s_add_u32 m0, s70, 3072
  s_nop 0
  buffer_load_dwordx4 v23, s[8:11], s39 offen lds
  s_add_u32 s39, s39, s37
  s_add_u32 m0, s70, 4096
  s_nop 0
  buffer_load_dwordx4 v23, s[8:11], s39 offen lds
  s_add_u32 s39, s39, s37
  s_add_u32 m0, s70, 5120
  s_nop 0
  buffer_load_dwordx4 v23, s[8:11], s39 offen lds
  s_add_u32 s39, s39, s37
  s_add_u32 m0, s70, 6144
  s_nop 0
  buffer_load_dwordx4 v23, s[8:11], s39 offen lds
  s_add_u32 s39, s39, s37
  s_add_u32 m0, s70, 7168
  s_nop 0
  buffer_load_dwordx4 v23, s[8:11], s39 offen lds
  s_barrier
  s_and_b32 s30, s2, 7
  s_lshr_b32 s31, s2, 3
  s_lshr_b32 s32, s30, 1
  s_lshl_b32 s32, s32, 2
  s_lshr_b32 s33, s31, 3
  s_add_u32 s14, s32, s33
  s_and_b32 s32, s30, 1
  s_lshl_b32 s32, s32, 3
  s_and_b32 s33, s31, 7
  s_add_u32 s15, s32, s33
  s_lshl_b32 s32, s30, 2
  s_lshr_b32 s33, s31, 3
  s_add_u32 s16, s32, s33
  s_and_b32 s17, s31, 7
  s_lshr_b32 s32, s30, 2
  s_lshl_b32 s32, s32, 3
  s_lshr_b32 s33, s31, 2
  s_add_u32 s18, s32, s33
  s_and_b32 s32, s30, 3
  s_lshl_b32 s32, s32, 2
  s_and_b32 s33, s31, 3
  s_add_u32 s19, s32, s33
  s_mov_b32 s62, 0x3fb8aa3b
  s_mov_b32 s63, 0x3fb8aa3b
  s_mov_b32 s64, 1.0
  s_mov_b32 s65, 1.0
  s_waitcnt vmcnt(0)
  v_and_b32 v20, 15, v1
  v_bfe_u32 v21, v1, 4, 1
  v_lshrrev_b32 v22, 5, v1
  v_bfe_u32 v24, v1, 2, 2
  v_lshl_add_u32 v24, v22, 2, v24
  v_lshlrev_b32 v24, 7, v24
  v_lshl_add_u32 v24, v21, 5, v24
  v_and_b32 v25, 3, v1
  v_lshl_add_u32 v24, v25, 3, v24
  v_add_u32 v24, s70, v24
  ds_read_b64_tr_b16 v[148:149], v24 offset:0
  ds_read_b64_tr_b16 v[150:151], v24 offset:1024
  ds_read_b64_tr_b16 v[152:153], v24 offset:64
  ds_read_b64_tr_b16 v[154:155], v24 offset:1088
  ds_read_b64_tr_b16 v[156:157], v24 offset:2048
  ds_read_b64_tr_b16 v[158:159], v24 offset:3072
  ds_read_b64_tr_b16 v[160:161], v24 offset:2112
  ds_read_b64_tr_b16 v[162:163], v24 offset:3136
  ds_read_b64_tr_b16 v[164:165], v24 offset:4096
  ds_read_b64_tr_b16 v[166:167], v24 offset:5120
  ds_read_b64_tr_b16 v[168:169], v24 offset:4160
  ds_read_b64_tr_b16 v[170:171], v24 offset:5184
  ds_read_b64_tr_b16 v[172:173], v24 offset:6144
  ds_read_b64_tr_b16 v[174:175], v24 offset:7168
  ds_read_b64_tr_b16 v[176:177], v24 offset:6208
  s_waitcnt lgkmcnt(14)
  ds_read_b64_tr_b16 v[178:179], v24 offset:7232
  v_and_b32 v26, 31, v1
  v_lshlrev_b32 v26, 4, v26
  s_cmp_eq_u32 s27, 0
  s_nop 0
  s_cbranch_scc1 L_up_plain_a
  v_lshrrev_b32 v25, 3, v20
  v_lshlrev_b32 v25, 4, v25
  v_and_b32 v26, 7, v20
  v_add_u32 v26, v26, v25
  s_sub_u32 s38, s27, 1
  s_lshl_b32 s38, s38, 3
  v_add_u32 v26, s38, v26
  v_lshlrev_b32 v26, 4, v26
  s_mov_b32 s38, 33792
  v_mul_lo_u32 v25, v21, s38
  v_add_u32 v26, v26, v25
  s_nop 1
L_up_plain_a:
  v_lshl_add_u32 v27, v22, 9, v26
  s_mov_b32 s36, s28
  s_mov_b32 s28, 0
  s_cmp_eq_u32 s26, 0
  s_cbranch_scc1 L_us_done_a1
  s_mov_b32 s39, s23
  s_waitcnt lgkmcnt(14)
  buffer_store_dwordx4 v[148:151], v27, s[4:7], s39 offen sc1
  s_add_u32 s38, s39, s25
  s_waitcnt lgkmcnt(12)
  buffer_store_dwordx4 v[152:155], v27, s[4:7], s38 offen sc1
  s_add_u32 s39, s39, s24
  s_waitcnt lgkmcnt(10)
  buffer_store_dwordx4 v[156:159], v27, s[4:7], s39 offen sc1
  s_add_u32 s38, s39, s25
  s_waitcnt lgkmcnt(8)
  buffer_store_dwordx4 v[160:163], v27, s[4:7], s38 offen sc1
  s_add_u32 s39, s39, s24
  s_waitcnt lgkmcnt(6)
  buffer_store_dwordx4 v[164:167], v27, s[4:7], s39 offen sc1
  s_add_u32 s38, s39, s25
  s_waitcnt lgkmcnt(4)
  buffer_store_dwordx4 v[168:171], v27, s[4:7], s38 offen sc1
  s_add_u32 s39, s39, s24
  s_cmp_lt_u32 s26, 4
  s_cbranch_scc1 L_us_kb_a1
  s_waitcnt lgkmcnt(2)
  buffer_store_dwordx4 v[172:175], v27, s[4:7], s39 offen sc1
  s_add_u32 s38, s39, s25
  s_waitcnt lgkmcnt(0)
  buffer_store_dwordx4 v[176:179], v27, s[4:7], s38 offen sc1
  s_add_u32 s39, s39, s24
  s_nop 0
L_us_kb_a1:
  s_cmp_eq_u32 s28, 0
  s_cbranch_scc1 L_us_done_a1
  s_mov_b32 exec_hi, 0
  buffer_store_dword v32, v26, s[4:7], s29 offen sc1
  s_add_u32 s39, s29, s25
  buffer_store_dword v33, v26, s[4:7], s39 offen sc1
  s_mov_b64 exec, -1
L_us_done_a1:
  s_cmp_eq_u32 s36, 0
  s_cbranch_scc1 L_a_nocs
  v_mov_b32 v28, 0
  v_mov_b32 v29, 0
  v_dot2c_f32_bf16 v28, 0x3f803f80, v148
  v_dot2c_f32_bf16 v29, 0x3f803f80, v152
  v_dot2c_f32_bf16 v28, 0x3f803f80, v149
  v_dot2c_f32_bf16 v29, 0x3f803f80, v153
  v_dot2c_f32_bf16 v28, 0x3f803f80, v150
  v_dot2c_f32_bf16 v29, 0x3f803f80, v154
  v_dot2c_f32_bf16 v28, 0x3f803f80, v151
  v_dot2c_f32_bf16 v29, 0x3f803f80, v155
  v_dot2c_f32_bf16 v28, 0x3f803f80, v156
  v_dot2c_f32_bf16 v29, 0x3f803f80, v160
  v_dot2c_f32_bf16 v28, 0x3f803f80, v157
  v_dot2c_f32_bf16 v29, 0x3f803f80, v161
  v_dot2c_f32_bf16 v28, 0x3f803f80, v158
  v_dot2c_f32_bf16 v29, 0x3f803f80, v162
  v_dot2c_f32_bf16 v28, 0x3f803f80, v159
  v_dot2c_f32_bf16 v29, 0x3f803f80, v163
  v_dot2c_f32_bf16 v28, 0x3f803f80, v164
  v_dot2c_f32_bf16 v29, 0x3f803f80, v168
  v_dot2c_f32_bf16 v28, 0x3f803f80, v165
  v_dot2c_f32_bf16 v29, 0x3f803f80, v169
  v_dot2c_f32_bf16 v28, 0x3f803f80, v166
  v_dot2c_f32_bf16 v29, 0x3f803f80, v170
  v_dot2c_f32_bf16 v28, 0x3f803f80, v167
  v_dot2c_f32_bf16 v29, 0x3f803f80, v171
  v_dot2c_f32_bf16 v28, 0x3f803f80, v172
  v_dot2c_f32_bf16 v29, 0x3f803f80, v176
  v_dot2c_f32_bf16 v28, 0x3f803f80, v173
  v_dot2c_f32_bf16 v29, 0x3f803f80, v177
  v_dot2c_f32_bf16 v28, 0x3f803f80, v174
  v_dot2c_f32_bf16 v29, 0x3f803f80, v178
  v_dot2c_f32_bf16 v28, 0x3f803f80, v175
  v_dot2c_f32_bf16 v29, 0x3f803f80, v179
  s_nop 1
  v_mov_b32 v30, v28
  s_nop 1
  v_permlane32_swap_b32 v28, v30
  v_add_f32 v28, v28, v30
  v_cvt_pk_bf16_f32 v31, v28, v28
  v_lshlrev_b32 v30, 16, v31
  v_sub_f32 v30, v28, v30
  v_cvt_pk_bf16_f32 v32, v28, v30
  v_mov_b32 v30, v29
  s_nop 1
  v_permlane32_swap_b32 v29, v30
  v_add_f32 v29, v29, v30
  v_cvt_pk_bf16_f32 v31, v29, v29
  v_lshlrev_b32 v30, 16, v31
  v_sub_f32 v30, v29, v30
  v_cvt_pk_bf16_f32 v33, v29, v30
  s_mov_b32 exec_hi, 0
  buffer_store_dword v32, v26, s[4:7], s29 offen sc1
  s_add_u32 s29, s29, s25
  buffer_store_dword v33, v26, s[4:7], s29 offen sc1
  s_mov_b64 exec, -1
L_a_nocs:
  s_mov_b32 s8, s58
  s_mov_b32 s9, s59
  s_mov_b32 s10, 0x100
  s_mov_b32 s11, 0x20000
  v_mov_b32 v20, 0
  buffer_load_dword v21, v20, s[8:11], 0 offen sc1
  s_waitcnt vmcnt(0) lgkmcnt(0)
  s_barrier
  s_mov_b32 s38, 0
L_prep_zp:
  v_cmp_le_u32 vcc, 8, v21
  s_nop 4
  s_cbranch_vccnz L_prep_zd
  s_add_u32 s38, s38, 1
  s_cmp_gt_u32 s38, 200000
  s_cbranch_scc1 L_prep_zd
  buffer_load_dword v21, v20, s[8:11], 0 offen sc1
  s_waitcnt vmcnt(0)
  s_branch L_prep_zp
L_prep_zd:
  s_lshl_b32 s39, s13, 3
  s_add_u32 s39, s39, 1
  s_lshl_b32 s38, s2, 7
  v_mov_b32 v214, s38
  v_mov_b32 v215, s39
  s_mov_b64 exec, 1
  buffer_store_dword v215, v214, s[4:7], 0 offen offset:0 sc1
  s_mov_b64 exec, -1
  s_branch L_prep_end
L_pw1:
  s_mov_b32 s8, s44
  s_mov_b32 s9, s45
  s_mov_b32 s10, 0x4000
  s_mov_b32 s11, 0x20000
  s_and_b32 s30, s2, 1
  s_lshl_b32 s30, s30, 3
  s_bfe_u32 s31, s2, 0x30003
  s_add_u32 s30, s30, s31
  s_lshl_b32 s30, s30, 10
  s_mov_b32 m0, 161792
  s_nop 0
  buffer_load_dwordx4 v2, s[8:11], s30 offen lds
  s_mov_b32 s8, s40
  s_mov_b32 s9, s41
  s_mov_b32 s10, 0x200000
  s_mov_b32 s11, 0x20000
  s_lshl_b32 s20, s2, 13
  s_mov_b32 m0, 139264
  s_add_u32 s21, s20, 0
  buffer_load_dwordx4 v2, s[8:11], s21 offen lds
  s_mov_b32 m0, 140288
  s_add_u32 s21, s20, 1024
  buffer_load_dwordx4 v2, s[8:11], s21 offen lds
  s_mov_b32 m0, 141312
  s_add_u32 s21, s20, 2048
  buffer_load_dwordx4 v2, s[8:11], s21 offen lds
  s_mov_b32 m0, 142336
  s_add_u32 s21, s20, 3072
  buffer_load_dwordx4 v2, s[8:11], s21 offen lds
  s_mov_b32 m0, 143360
  s_add_u32 s21, s20, 4096
  buffer_load_dwordx4 v2, s[8:11], s21 offen lds
  s_mov_b32 m0, 144384
  s_add_u32 s21, s20, 5120
  buffer_load_dwordx4 v2, s[8:11], s21 offen lds
  s_mov_b32 m0, 145408
  s_add_u32 s21, s20, 6144
  buffer_load_dwordx4 v2, s[8:11], s21 offen lds
  s_mov_b32 m0, 146432
  s_add_u32 s21, s20, 7168
  buffer_load_dwordx4 v2, s[8:11], s21 offen lds
  s_barrier
  v_and_b32 v20, 7, v1
  v_bfe_u32 v21, v1, 3, 1
  v_lshrrev_b32 v22, 4, v1
  v_lshlrev_b32 v25, 10, v20
  v_lshl_add_u32 v25, v22, 5, v25
  v_lshl_add_u32 v25, v21, 3, v25
  v_add_u32 v25, 139264, v25
  v_lshl_add_u32 v26, v21, 5, v20
  v_lshlrev_b32 v26, 4, v26
  v_lshl_add_u32 v26, v22, 10, v26
  s_lshr_b32 s36, s2, 2
  s_lshl_b32 s36, s36, 15
  s_and_b32 s37, s2, 3
  s_lshl_b32 s37, s37, 7
  s_add_u32 s36, s36, s37
  s_add_u32 s36, s36, 10485760
  s_and_b32 s30, s2, 7
  s_lshr_b32 s31, s2, 3
  s_lshr_b32 s32, s30, 1
  s_lshl_b32 s32, s32, 2
  s_lshr_b32 s33, s31, 3
  s_add_u32 s14, s32, s33
  s_and_b32 s32, s30, 1
  s_lshl_b32 s32, s32, 3
  s_and_b32 s33, s31, 7
  s_add_u32 s15, s32, s33
  s_lshl_b32 s32, s30, 2
  s_lshr_b32 s33, s31, 3
  s_add_u32 s16, s32, s33
  s_and_b32 s17, s31, 7
  s_lshr_b32 s32, s30, 2
  s_lshl_b32 s32, s32, 3
  s_lshr_b32 s33, s31, 2
  s_add_u32 s18, s32, s33
  s_and_b32 s32, s30, 3
  s_lshl_b32 s32, s32, 2
  s_and_b32 s33, s31, 3
  s_add_u32 s19, s32, s33
  s_mov_b32 s62, 0x3fb8aa3b
  s_mov_b32 s63, 0x3fb8aa3b
  s_mov_b32 s64, 1.0
  s_mov_b32 s65, 1.0
  s_cmp_lg_u32 s12, 0
  s_cbranch_scc1 L_ub_s2
  s_cmp_ge_u32 s2, 192
  s_cbranch_scc1 L_ub_wo
  s_mov_b32 s8, s42
  s_mov_b32 s9, s43
  s_mov_b32 s10, 0x180000
  s_mov_b32 s11, 0x20000
  s_lshr_b32 s30, s2, 3
  s_and_b32 s31, s2, 7
  s_mov_b32 s21, 3072
  s_mul_i32 s22, s31, 196608
  s_lshl_b32 s32, s30, 7
  s_add_u32 s22, s22, s32
  s_lshr_b32 s32, s30, 3
  s_add_u32 s33, s32, 2
  s_cmp_ge_u32 s33, 3
  s_cselect_b32 s35, 3, 0
  s_sub_u32 s33, s33, s35
  s_lshl_b32 s34, s30, 1
  s_and_b32 s34, s34, 15
  s_mul_i32 s34, s34, 3
  s_add_u32 s34, s34, s33
  s_mul_i32 s34, s34, 33792
  s_add_u32 s34, s34, 1048576
  s_mov_b32 s25, 101376
  s_mov_b32 s27, 0
  s_branch L_ub_cs
L_ub_wo:
  s_mov_b32 s8, s46
  s_mov_b32 s9, s47
  s_mov_b32 s10, 0x80000
  s_mov_b32 s11, 0x20000
  s_sub_u32 s20, s2, 192
  s_lshr_b32 s30, s20, 3
  s_and_b32 s31, s20, 7
  s_mov_b32 s21, 1024
  s_lshl_b32 s22, s31, 16
  s_lshl_b32 s32, s30, 7
  s_add_u32 s22, s22, s32
  s_lshl_b32 s23, s30, 16
  s_lshl_b32 s32, s31, 13
  s_add_u32 s23, s23, s32
  s_add_u32 s23, s23, 7340032
  s_mov_b32 s24, 2048
  s_mov_b32 s25, 1024
  s_mov_b32 s26, 4
  s_mov_b32 s27, 0
  s_mov_b32 s28, 0
  s_mov_b32 s29, 0
  s_branch L_ub_pdone
L_ub_s2:
  s_sub_u32 s20, s12, 1
  s_lshl_b32 s20, s20, 8
  s_add_u32 s20, s20, s2
  s_cmp_ge_u32 s20, 448
  s_cbranch_scc1 L_ub_w2
  s_cmp_ge_u32 s20, 224
  s_cbranch_scc1 L_ub_w3
  s_mov_b32 s8, s50
  s_mov_b32 s9, s51
  s_mov_b32 s10, 0x1c0000
  s_mov_b32 s11, 0x20000
  s_mov_b32 s27, 1
  s_branch L_ub_w13
L_ub_w3:
  s_mov_b32 s8, s52
  s_mov_b32 s9, s53
  s_mov_b32 s10, 0x1c0000
  s_mov_b32 s11, 0x20000
  s_sub_u32 s20, s20, 224
  s_mov_b32 s27, 2
L_ub_w13:
  s_lshr_b32 s30, s20, 3
  s_and_b32 s31, s20, 7
  s_mov_b32 s21, 3584
  s_mul_i32 s22, s31, 229376
  s_lshl_b32 s32, s30, 7
  s_add_u32 s22, s22, s32
  s_mul_i32 s34, s30, 135168
  s_add_u32 s34, s34, 3145728
  s_mov_b32 s25, 67584
L_ub_cs:
  s_lshl_b32 s35, s31, 12
  s_add_u32 s23, s34, s35
  s_mov_b32 s24, 1024
  s_mov_b32 s26, 4
  s_mov_b32 s28, 1
  s_lshr_b32 s35, s31, 2
  s_lshl_b32 s35, s35, 9
  s_add_u32 s29, s34, s35
  s_and_b32 s35, s31, 3
  s_lshl_b32 s35, s35, 2
  s_add_u32 s29, s29, s35
  s_add_u32 s29, s29, 32768
  s_branch L_ub_pdone
L_ub_w2:
  s_mov_b32 s8, s54
  s_mov_b32 s9, s55
  s_mov_b32 s10, 0x1c0000
  s_mov_b32 s11, 0x20000
  s_sub_u32 s20, s20, 448
  s_lshr_b32 s30, s20, 4
  s_bfe_u32 s31, s20, 0x30001
  s_and_b32 s33, s20, 1
  s_mov_b32 s21, 1024
  s_mul_i32 s22, s30, 114688
  s_lshl_b32 s32, s33, 16
  s_add_u32 s22, s22, s32
  s_lshl_b32 s32, s31, 7
  s_add_u32 s22, s22, s32
  s_mul_i32 s23, s31, 229376
  s_lshr_b32 s32, s30, 2
  s_mul_i32 s32, s32, 57344
  s_add_u32 s23, s23, s32
  s_and_b32 s32, s30, 3
  s_lshl_b32 s32, s32, 11
  s_add_u32 s23, s23, s32
  s_lshl_b32 s32, s33, 15
  s_add_u32 s23, s23, s32
  s_add_u32 s23, s23, 8388608
  s_mov_b32 s24, 8192
  s_mov_b32 s25, 1024
  s_sub_u32 s26, 4, s33
  s_mov_b32 s27, 0
  s_mov_b32 s28, 0
  s_mov_b32 s29, 0
  s_cmp_lt_u32 s20, 256
  s_cselect_b32 s26, s26, 0
L_ub_pdone:
  s_waitcnt vmcnt(0)
  ds_read_b64 v[148:149], v25 offset:0
  ds_read_b64 v[150:151], v25 offset:16
  ds_read_b64 v[152:153], v25 offset:128
  ds_read_b64 v[154:155], v25 offset:144
  ds_read_b64 v[156:157], v25 offset:256
  ds_read_b64 v[158:159], v25 offset:272
  ds_read_b64 v[160:161], v25 offset:384
  ds_read_b64 v[162:163], v25 offset:400
  ds_read_b64 v[164:165], v25 offset:512
  ds_read_b64 v[166:167], v25 offset:528
  ds_read_b64 v[168:169], v25 offset:640
  ds_read_b64 v[170:171], v25 offset:656
  ds_read_b64 v[172:173], v25 offset:768
  ds_read_b64 v[174:175], v25 offset:784
  ds_read_b64 v[176:177], v25 offset:896
  s_waitcnt lgkmcnt(14)
  ds_read_b64 v[178:179], v25 offset:912
  s_add_u32 s20, s36, 0
  s_waitcnt lgkmcnt(14)
  buffer_store_dwordx4 v[148:151], v26, s[4:7], s20 offen sc1
  s_add_u32 s20, s36, 4096
  s_waitcnt lgkmcnt(12)
  buffer_store_dwordx4 v[152:155], v26, s[4:7], s20 offen sc1
  s_add_u32 s20, s36, 8192
  s_waitcnt lgkmcnt(10)
  buffer_store_dwordx4 v[156:159], v26, s[4:7], s20 offen sc1
  s_add_u32 s20, s36, 12288
  s_waitcnt lgkmcnt(8)
  buffer_store_dwordx4 v[160:163], v26, s[4:7], s20 offen sc1
  s_add_u32 s20, s36, 16384
  s_waitcnt lgkmcnt(6)
  buffer_store_dwordx4 v[164:167], v26, s[4:7], s20 offen sc1
  s_add_u32 s20, s36, 20480
  s_waitcnt lgkmcnt(4)
  buffer_store_dwordx4 v[168:171], v26, s[4:7], s20 offen sc1
  s_add_u32 s20, s36, 24576
  s_waitcnt lgkmcnt(2)
  buffer_store_dwordx4 v[172:175], v26, s[4:7], s20 offen sc1
  s_add_u32 s20, s36, 28672
  s_waitcnt lgkmcnt(0)
  buffer_store_dwordx4 v[176:179], v26, s[4:7], s20 offen sc1
  s_mov_b32 s70, 98304
  s_waitcnt vmcnt(0) lgkmcnt(0)
  s_barrier
  v_lshrrev_b32 v23, 3, v1
  v_mul_lo_u32 v23, v23, s21
  v_and_b32 v24, 7, v1
  v_lshl_add_u32 v23, v24, 4, v23
  s_lshl_b32 s37, s21, 3
  s_mov_b32 s39, s22
  s_add_u32 m0, s70, 0
  s_nop 0
  buffer_load_dwordx4 v23, s[8:11], s39 offen lds
  s_add_u32 s39, s39, s37
  s_add_u32 m0, s70, 1024
  s_nop 0
  buffer_load_dwordx4 v23, s[8:11], s39 offen lds
  s_add_u32 s39, s39, s37
  s_add_u32 m0, s70, 2048
  s_nop 0
  buffer_load_dwordx4 v23, s[8:11], s39 offen lds
  s_add_u32 s39, s39, s37
  s_add_u32 m0, s70, 3072
  s_nop 0
  buffer_load_dwordx4 v23, s[8:11], s39 offen lds
  s_add_u32 s39, s39, s37
  s_add_u32 m0, s70, 4096
  s_nop 0
  buffer_load_dwordx4 v23, s[8:11], s39 offen lds
  s_add_u32 s39, s39, s37
  s_add_u32 m0, s70, 5120
  s_nop 0
  buffer_load_dwordx4 v23, s[8:11], s39 offen lds
  s_add_u32 s39, s39, s37
  s_add_u32 m0, s70, 6144
  s_nop 0
  buffer_load_dwordx4 v23, s[8:11], s39 offen lds
  s_add_u32 s39, s39, s37
  s_add_u32 m0, s70, 7168
  s_nop 0
  buffer_load_dwordx4 v23, s[8:11], s39 offen lds
  s_branch L_prep_s2
L_pw2:
  s_mov_b32 s8, s40
  s_mov_b32 s9, s41
  s_mov_b32 s10, 0x200000
  s_mov_b32 s11, 0x20000
  v_and_b32 v34, 7, v1
  v_lshrrev_b32 v35, 3, v1
  v_lshlrev_b32 v22, 10, v34
  v_lshl_add_u32 v22, v35, 4, v22
  s_lshl_b32 s20, s2, 13
  buffer_load_dwordx4 v[148:151], v22, s[8:11], s20 offen offset:0
  buffer_load_dwordx4 v[152:155], v22, s[8:11], s20 offen offset:128
  buffer_load_dwordx4 v[156:159], v22, s[8:11], s20 offen offset:256
  buffer_load_dwordx4 v[160:163], v22, s[8:11], s20 offen offset:384
  buffer_load_dwordx4 v[164:167], v22, s[8:11], s20 offen offset:512
  buffer_load_dwordx4 v[168:171], v22, s[8:11], s20 offen offset:640
  buffer_load_dwordx4 v[172:175], v22, s[8:11], s20 offen offset:768
  buffer_load_dwordx4 v[176:179], v22, s[8:11], s20 offen offset:896
  s_barrier
  s_and_b32 s30, s2, 7
  s_lshr_b32 s31, s2, 3
  s_lshr_b32 s32, s30, 1
  s_lshl_b32 s32, s32, 2
  s_lshr_b32 s33, s31, 3
  s_add_u32 s14, s32, s33
  s_and_b32 s32, s30, 1
  s_lshl_b32 s32, s32, 3
  s_and_b32 s33, s31, 7
  s_add_u32 s15, s32, s33
  s_lshl_b32 s32, s30, 2
  s_lshr_b32 s33, s31, 3
  s_add_u32 s16, s32, s33
  s_and_b32 s17, s31, 7
  s_lshr_b32 s32, s30, 2
  s_lshl_b32 s32, s32, 3
  s_lshr_b32 s33, s31, 2
  s_add_u32 s18, s32, s33
  s_and_b32 s32, s30, 3
  s_lshl_b32 s32, s32, 2
  s_and_b32 s33, s31, 3
  s_add_u32 s19, s32, s33
  s_mov_b32 s62, 0x3fb8aa3b
  s_mov_b32 s63, 0x3fb8aa3b
  s_mov_b32 s64, 1.0
  s_mov_b32 s65, 1.0
  s_cmp_lg_u32 s12, 0
  s_cbranch_scc1 L_uc_s2
  s_cmp_ge_u32 s2, 192
  s_cbranch_scc1 L_uc_wo
  s_mov_b32 s8, s42
  s_mov_b32 s9, s43
  s_mov_b32 s10, 0x180000
  s_mov_b32 s11, 0x20000
  s_lshr_b32 s30, s2, 3
  s_and_b32 s31, s2, 7
  s_mov_b32 s21, 3072
  s_mul_i32 s22, s31, 196608
  s_lshl_b32 s32, s30, 7
  s_add_u32 s22, s22, s32
  s_lshr_b32 s32, s30, 3
  s_add_u32 s33, s32, 2
  s_cmp_ge_u32 s33, 3
  s_cselect_b32 s35, 3, 0
  s_sub_u32 s33, s33, s35
  s_lshl_b32 s34, s30, 1
  s_and_b32 s34, s34, 15
  s_mul_i32 s34, s34, 3
  s_add_u32 s34, s34, s33
  s_mul_i32 s34, s34, 33792
  s_add_u32 s34, s34, 1048576
  s_mov_b32 s25, 101376
  s_mov_b32 s27, 0
  s_branch L_uc_cs
L_uc_wo:
  s_mov_b32 s8, s46
  s_mov_b32 s9, s47
  s_mov_b32 s10, 0x80000
  s_mov_b32 s11, 0x20000
  s_sub_u32 s20, s2, 192
  s_lshr_b32 s30, s20, 3
  s_and_b32 s31, s20, 7
  s_mov_b32 s21, 1024
  s_lshl_b32 s22, s31, 16
  s_lshl_b32 s32, s30, 7
  s_add_u32 s22, s22, s32
  s_lshl_b32 s23, s30, 16
  s_lshl_b32 s32, s31, 13
  s_add_u32 s23, s23, s32
  s_add_u32 s23, s23, 7340032
  s_mov_b32 s24, 2048
  s_mov_b32 s25, 1024
  s_mov_b32 s26, 4
  s_mov_b32 s27, 0
  s_mov_b32 s28, 0
  s_mov_b32 s29, 0
  s_branch L_uc_pdone
L_uc_s2:
  s_sub_u32 s20, s12, 1
  s_lshl_b32 s20, s20, 8
  s_add_u32 s20, s20, s2
  s_cmp_ge_u32 s20, 448
  s_cbranch_scc1 L_uc_w2
  s_cmp_ge_u32 s20, 224
  s_cbranch_scc1 L_uc_w3
  s_mov_b32 s8, s50
  s_mov_b32 s9, s51
  s_mov_b32 s10, 0x1c0000
  s_mov_b32 s11, 0x20000
  s_mov_b32 s27, 1
  s_branch L_uc_w13
L_uc_w3:
  s_mov_b32 s8, s52
  s_mov_b32 s9, s53
  s_mov_b32 s10, 0x1c0000
  s_mov_b32 s11, 0x20000
  s_sub_u32 s20, s20, 224
  s_mov_b32 s27, 2
L_uc_w13:
  s_lshr_b32 s30, s20, 3
  s_and_b32 s31, s20, 7
  s_mov_b32 s21, 3584
  s_mul_i32 s22, s31, 229376
  s_lshl_b32 s32, s30, 7
  s_add_u32 s22, s22, s32
  s_mul_i32 s34, s30, 135168
  s_add_u32 s34, s34, 3145728
  s_mov_b32 s25, 67584
L_uc_cs:
  s_lshl_b32 s35, s31, 12
  s_add_u32 s23, s34, s35
  s_mov_b32 s24, 1024
  s_mov_b32 s26, 4
  s_mov_b32 s28, 1
  s_lshr_b32 s35, s31, 2
  s_lshl_b32 s35, s35, 9
  s_add_u32 s29, s34, s35
  s_and_b32 s35, s31, 3
  s_lshl_b32 s35, s35, 2
  s_add_u32 s29, s29, s35
  s_add_u32 s29, s29, 32768
  s_branch L_uc_pdone
L_uc_w2:
  s_mov_b32 s8, s54
  s_mov_b32 s9, s55
  s_mov_b32 s10, 0x1c0000
  s_mov_b32 s11, 0x20000
  s_sub_u32 s20, s20, 448
  s_lshr_b32 s30, s20, 4
  s_bfe_u32 s31, s20, 0x30001
  s_and_b32 s33, s20, 1
  s_mov_b32 s21, 1024
  s_mul_i32 s22, s30, 114688
  s_lshl_b32 s32, s33, 16
  s_add_u32 s22, s22, s32
  s_lshl_b32 s32, s31, 7
  s_add_u32 s22, s22, s32
  s_mul_i32 s23, s31, 229376
  s_lshr_b32 s32, s30, 2
  s_mul_i32 s32, s32, 57344
  s_add_u32 s23, s23, s32
  s_and_b32 s32, s30, 3
  s_lshl_b32 s32, s32, 11
  s_add_u32 s23, s23, s32
  s_lshl_b32 s32, s33, 15
  s_add_u32 s23, s23, s32
  s_add_u32 s23, s23, 8388608
  s_mov_b32 s24, 8192
  s_mov_b32 s25, 1024
  s_sub_u32 s26, 4, s33
  s_mov_b32 s27, 0
  s_mov_b32 s28, 0
  s_mov_b32 s29, 0
  s_cmp_lt_u32 s20, 256
  s_cselect_b32 s26, s26, 0
L_uc_pdone:
  v_mov_b32 v28, 0
  v_mov_b32 v29, 0
  s_waitcnt vmcnt(0)
  v_dot2c_f32_bf16 v28, 0x3f803f80, v148
  v_dot2c_f32_bf16 v29, v148, v148
  v_dot2c_f32_bf16 v28, 0x3f803f80, v149
  v_dot2c_f32_bf16 v29, v149, v149
  v_dot2c_f32_bf16 v28, 0x3f803f80, v150
  v_dot2c_f32_bf16 v29, v150, v150
  v_dot2c_f32_bf16 v28, 0x3f803f80, v151
  v_dot2c_f32_bf16 v29, v151, v151
  v_dot2c_f32_bf16 v28, 0x3f803f80, v152
  v_dot2c_f32_bf16 v29, v152, v152
  v_dot2c_f32_bf16 v28, 0x3f803f80, v153
  v_dot2c_f32_bf16 v29, v153, v153
  v_dot2c_f32_bf16 v28, 0x3f803f80, v154
  v_dot2c_f32_bf16 v29, v154, v154
  v_dot2c_f32_bf16 v28, 0x3f803f80, v155
  v_dot2c_f32_bf16 v29, v155, v155
  v_dot2c_f32_bf16 v28, 0x3f803f80, v156
  v_dot2c_f32_bf16 v29, v156, v156
  v_dot2c_f32_bf16 v28, 0x3f803f80, v157
  v_dot2c_f32_bf16 v29, v157, v157
  v_dot2c_f32_bf16 v28, 0x3f803f80, v158
  v_dot2c_f32_bf16 v29, v158, v158
  v_dot2c_f32_bf16 v28, 0x3f803f80, v159
  v_dot2c_f32_bf16 v29, v159, v159
  v_dot2c_f32_bf16 v28, 0x3f803f80, v160
  v_dot2c_f32_bf16 v29, v160, v160
  v_dot2c_f32_bf16 v28, 0x3f803f80, v161
  v_dot2c_f32_bf16 v29, v161, v161
  v_dot2c_f32_bf16 v28, 0x3f803f80, v162
  v_dot2c_f32_bf16 v29, v162, v162
  v_dot2c_f32_bf16 v28, 0x3f803f80, v163
  v_dot2c_f32_bf16 v29, v163, v163
  v_dot2c_f32_bf16 v28, 0x3f803f80, v164
  v_dot2c_f32_bf16 v29, v164, v164
  v_dot2c_f32_bf16 v28, 0x3f803f80, v165
  v_dot2c_f32_bf16 v29, v165, v165
  v_dot2c_f32_bf16 v28, 0x3f803f80, v166
  v_dot2c_f32_bf16 v29, v166, v166
  v_dot2c_f32_bf16 v28, 0x3f803f80, v167
  v_dot2c_f32_bf16 v29, v167, v167
  v_dot2c_f32_bf16 v28, 0x3f803f80, v168
  v_dot2c_f32_bf16 v29, v168, v168
  v_dot2c_f32_bf16 v28, 0x3f803f80, v169
  v_dot2c_f32_bf16 v29, v169, v169
  v_dot2c_f32_bf16 v28, 0x3f803f80, v170
  v_dot2c_f32_bf16 v29, v170, v170
  v_dot2c_f32_bf16 v28, 0x3f803f80, v171
  v_dot2c_f32_bf16 v29, v171, v171
  v_dot2c_f32_bf16 v28, 0x3f803f80, v172
  v_dot2c_f32_bf16 v29, v172, v172
  v_dot2c_f32_bf16 v28, 0x3f803f80, v173
  v_dot2c_f32_bf16 v29, v173, v173
  v_dot2c_f32_bf16 v28, 0x3f803f80, v174
  v_dot2c_f32_bf16 v29, v174, v174
  v_dot2c_f32_bf16 v28, 0x3f803f80, v175
  v_dot2c_f32_bf16 v29, v175, v175
  v_dot2c_f32_bf16 v28, 0x3f803f80, v176
  v_dot2c_f32_bf16 v29, v176, v176
  v_dot2c_f32_bf16 v28, 0x3f803f80, v177
  v_dot2c_f32_bf16 v29, v177, v177
  v_dot2c_f32_bf16 v28, 0x3f803f80, v178
  v_dot2c_f32_bf16 v29, v178, v178
  v_dot2c_f32_bf16 v28, 0x3f803f80, v179
  v_dot2c_f32_bf16 v29, v179, v179
  s_nop 1
  v_add_f32_dpp v28, v28, v28 row_ror:8 row_mask:0xf bank_mask:0xf
  v_add_f32_dpp v29, v29, v29 row_ror:8 row_mask:0xf bank_mask:0xf
  v_mov_b32 v30, v28
  s_nop 1
  v_permlane16_swap_b32 v28, v30
  v_add_f32 v28, v28, v30
  v_mov_b32 v30, v28
  s_nop 1
  v_permlane32_swap_b32 v28, v30
  v_add_f32 v28, v28, v30
  v_mov_b32 v30, v29
  s_nop 1
  v_permlane16_swap_b32 v29, v30
  v_add_f32 v29, v29, v30
  v_mov_b32 v30, v29
  s_nop 1
  v_permlane32_swap_b32 v29, v30
  v_add_f32 v29, v29, v30
  v_cmp_eq_u32 vcc, 0, v35
  s_nop 1
  v_cndmask_b32 v36, 0, v28, vcc
  v_cndmask_b32 v37, 0, v29, vcc
  v_mov_b32 v38, 0
  v_mov_b32 v39, 0
  v_lshlrev_b32 v30, 8, v35
  v_lshl_add_u32 v30, v34, 3, v30
  s_lshr_b32 s36, s2, 2
  s_lshl_b32 s36, s36, 12
  s_and_b32 s20, s2, 3
  s_lshl_b32 s20, s20, 6
  s_add_u32 s36, s36, s20
  s_add_u32 s36, s36, 18874368
  buffer_store_dwordx2 v[36:37], v30, s[4:7], s36 offen sc1
  buffer_store_dwordx2 v[38:39], v30, s[4:7], s36 offen offset:2048 sc1
  s_mov_b32 s70, 106496
  s_waitcnt vmcnt(0) lgkmcnt(0)
  s_barrier
  v_lshrrev_b32 v23, 3, v1
  v_mul_lo_u32 v23, v23, s21
  v_and_b32 v24, 7, v1
  v_lshl_add_u32 v23, v24, 4, v23
  s_lshl_b32 s37, s21, 3
  s_mov_b32 s39, s22
  s_add_u32 m0, s70, 0
  s_nop 0
  buffer_load_dwordx4 v23, s[8:11], s39 offen lds
  s_add_u32 s39, s39, s37
  s_add_u32 m0, s70, 1024
  s_nop 0
  buffer_load_dwordx4 v23, s[8:11], s39 offen lds
  s_add_u32 s39, s39, s37
  s_add_u32 m0, s70, 2048
  s_nop 0
  buffer_load_dwordx4 v23, s[8:11], s39 offen lds
  s_add_u32 s39, s39, s37
  s_add_u32 m0, s70, 3072
  s_nop 0
  buffer_load_dwordx4 v23, s[8:11], s39 offen lds
  s_add_u32 s39, s39, s37
  s_add_u32 m0, s70, 4096
  s_nop 0
  buffer_load_dwordx4 v23, s[8:11], s39 offen lds
  s_add_u32 s39, s39, s37
  s_add_u32 m0, s70, 5120
  s_nop 0
  buffer_load_dwordx4 v23, s[8:11], s39 offen lds
  s_add_u32 s39, s39, s37
  s_add_u32 m0, s70, 6144
  s_nop 0
  buffer_load_dwordx4 v23, s[8:11], s39 offen lds
  s_add_u32 s39, s39, s37
  s_add_u32 m0, s70, 7168
  s_nop 0
  buffer_load_dwordx4 v23, s[8:11], s39 offen lds
  s_branch L_prep_s2
L_pw3:
  s_cmp_ge_u32 s2, 8
  s_cbranch_scc1 L_pw3_a
  v_mov_b32 v20, 0
  v_mov_b32 v21, 0
  v_mov_b32 v22, 0
  v_mov_b32 v23, 0
  s_lshl_b32 s20, s2, 12
  buffer_store_dwordx4 v[20:23], v2, s[4:7], s20 offen offset:0 sc1
  buffer_store_dwordx4 v[20:23], v2, s[4:7], s20 offen offset:1024 sc1
  buffer_store_dwordx4 v[20:23], v2, s[4:7], s20 offen offset:2048 sc1
  buffer_store_dwordx4 v[20:23], v2, s[4:7], s20 offen offset:3072 sc1
  s_nop 1
L_pw3_a:
  s_barrier
  s_cmp_ge_u32 s2, 8
  s_cbranch_scc1 L_pw3_nz2
  s_waitcnt vmcnt(0)
  s_mov_b32 s8, s58
  s_mov_b32 s9, s59
  s_mov_b32 s10, 0x100
  s_mov_b32 s11, 0x20000
  v_mov_b32 v20, 0
  v_mov_b32 v21, 1
  s_mov_b64 exec, 1
  buffer_atomic_add v21, v20, s[8:11], 0 offen sc1
  s_mov_b64 exec, -1
L_pw3_nz2:
  s_cmp_lg_u32 s12, 0
  s_cbranch_scc1 L_ud_s2
  s_cmp_ge_u32 s2, 192
  s_cbranch_scc1 L_ud_wo
  s_mov_b32 s8, s42
  s_mov_b32 s9, s43
  s_mov_b32 s10, 0x180000
  s_mov_b32 s11, 0x20000
  s_lshr_b32 s30, s2, 3
  s_and_b32 s31, s2, 7
  s_mov_b32 s21, 3072
  s_mul_i32 s22, s31, 196608
  s_lshl_b32 s32, s30, 7
  s_add_u32 s22, s22, s32
  s_lshr_b32 s32, s30, 3
  s_add_u32 s33, s32, 2
  s_cmp_ge_u32 s33, 3
  s_cselect_b32 s35, 3, 0
  s_sub_u32 s33, s33, s35
  s_lshl_b32 s34, s30, 1
  s_and_b32 s34, s34, 15
  s_mul_i32 s34, s34, 3
  s_add_u32 s34, s34, s33
  s_mul_i32 s34, s34, 33792
  s_add_u32 s34, s34, 1048576
  s_mov_b32 s25, 101376
  s_mov_b32 s27, 0
  s_branch L_ud_cs
L_ud_wo:
  s_mov_b32 s8, s46
  s_mov_b32 s9, s47
  s_mov_b32 s10, 0x80000
  s_mov_b32 s11, 0x20000
  s_sub_u32 s20, s2, 192
  s_lshr_b32 s30, s20, 3
  s_and_b32 s31, s20, 7
  s_mov_b32 s21, 1024
  s_lshl_b32 s22, s31, 16
  s_lshl_b32 s32, s30, 7
  s_add_u32 s22, s22, s32
  s_lshl_b32 s23, s30, 16
  s_lshl_b32 s32, s31, 13
  s_add_u32 s23, s23, s32
  s_add_u32 s23, s23, 7340032
  s_mov_b32 s24, 2048
  s_mov_b32 s25, 1024
  s_mov_b32 s26, 4
  s_mov_b32 s27, 0
  s_mov_b32 s28, 0
  s_mov_b32 s29, 0
  s_branch L_ud_pdone
L_ud_s2:
  s_sub_u32 s20, s12, 1
  s_lshl_b32 s20, s20, 8
  s_add_u32 s20, s20, s2
  s_cmp_ge_u32 s20, 448
  s_cbranch_scc1 L_ud_w2
  s_cmp_ge_u32 s20, 224
  s_cbranch_scc1 L_ud_w3
  s_mov_b32 s8, s50
  s_mov_b32 s9, s51
  s_mov_b32 s10, 0x1c0000
  s_mov_b32 s11, 0x20000
  s_mov_b32 s27, 1
  s_branch L_ud_w13
L_ud_w3:
  s_mov_b32 s8, s52
  s_mov_b32 s9, s53
  s_mov_b32 s10, 0x1c0000
  s_mov_b32 s11, 0x20000
  s_sub_u32 s20, s20, 224
  s_mov_b32 s27, 2
L_ud_w13:
  s_lshr_b32 s30, s20, 3
  s_and_b32 s31, s20, 7
  s_mov_b32 s21, 3584
  s_mul_i32 s22, s31, 229376
  s_lshl_b32 s32, s30, 7
  s_add_u32 s22, s22, s32
  s_mul_i32 s34, s30, 135168
  s_add_u32 s34, s34, 3145728
  s_mov_b32 s25, 67584
L_ud_cs:
  s_lshl_b32 s35, s31, 12
  s_add_u32 s23, s34, s35
  s_mov_b32 s24, 1024
  s_mov_b32 s26, 4
  s_mov_b32 s28, 1
  s_lshr_b32 s35, s31, 2
  s_lshl_b32 s35, s35, 9
  s_add_u32 s29, s34, s35
  s_and_b32 s35, s31, 3
  s_lshl_b32 s35, s35, 2
  s_add_u32 s29, s29, s35
  s_add_u32 s29, s29, 32768
  s_branch L_ud_pdone
L_ud_w2:
  s_mov_b32 s8, s54
  s_mov_b32 s9, s55
  s_mov_b32 s10, 0x1c0000
  s_mov_b32 s11, 0x20000
  s_sub_u32 s20, s20, 448
  s_lshr_b32 s30, s20, 4
  s_bfe_u32 s31, s20, 0x30001
  s_and_b32 s33, s20, 1
  s_mov_b32 s21, 1024
  s_mul_i32 s22, s30, 114688
  s_lshl_b32 s32, s33, 16
  s_add_u32 s22, s22, s32
  s_lshl_b32 s32, s31, 7
  s_add_u32 s22, s22, s32
  s_mul_i32 s23, s31, 229376
  s_lshr_b32 s32, s30, 2
  s_mul_i32 s32, s32, 57344
  s_add_u32 s23, s23, s32
  s_and_b32 s32, s30, 3
  s_lshl_b32 s32, s32, 11
  s_add_u32 s23, s23, s32
  s_lshl_b32 s32, s33, 15
  s_add_u32 s23, s23, s32
  s_add_u32 s23, s23, 8388608
  s_mov_b32 s24, 8192
  s_mov_b32 s25, 1024
  s_sub_u32 s26, 4, s33
  s_mov_b32 s27, 0
  s_mov_b32 s28, 0
  s_mov_b32 s29, 0
  s_cmp_lt_u32 s20, 256
  s_cselect_b32 s26, s26, 0
L_ud_pdone:
  s_mov_b32 s70, 114688
  v_lshrrev_b32 v23, 3, v1
  v_mul_lo_u32 v23, v23, s21
  v_and_b32 v24, 7, v1
  v_lshl_add_u32 v23, v24, 4, v23
  s_lshl_b32 s37, s21, 3
  s_mov_b32 s39, s22
  s_add_u32 m0, s70, 0
  s_nop 0
  buffer_load_dwordx4 v23, s[8:11], s39 offen lds
  s_add_u32 s39, s39, s37
  s_add_u32 m0, s70, 1024
  s_nop 0
  buffer_load_dwordx4 v23, s[8:11], s39 offen lds
  s_add_u32 s39, s39, s37
  s_add_u32 m0, s70, 2048
  s_nop 0
  buffer_load_dwordx4 v23, s[8:11], s39 offen lds
  s_add_u32 s39, s39, s37
  s_add_u32 m0, s70, 3072
  s_nop 0
  buffer_load_dwordx4 v23, s[8:11], s39 offen lds
  s_add_u32 s39, s39, s37
  s_add_u32 m0, s70, 4096
  s_nop 0
  buffer_load_dwordx4 v23, s[8:11], s39 offen lds
  s_add_u32 s39, s39, s37
  s_add_u32 m0, s70, 5120
  s_nop 0
  buffer_load_dwordx4 v23, s[8:11], s39 offen lds
  s_add_u32 s39, s39, s37
  s_add_u32 m0, s70, 6144
  s_nop 0
  buffer_load_dwordx4 v23, s[8:11], s39 offen lds
  s_add_u32 s39, s39, s37
  s_add_u32 m0, s70, 7168
  s_nop 0
  buffer_load_dwordx4 v23, s[8:11], s39 offen lds
  s_and_b32 s30, s2, 7
  s_lshr_b32 s31, s2, 3
  s_lshr_b32 s32, s30, 1
  s_lshl_b32 s32, s32, 2
  s_lshr_b32 s33, s31, 3
  s_add_u32 s14, s32, s33
  s_and_b32 s32, s30, 1
  s_lshl_b32 s32, s32, 3
  s_and_b32 s33, s31, 7
  s_add_u32 s15, s32, s33
  s_lshl_b32 s32, s30, 2
  s_lshr_b32 s33, s31, 3
  s_add_u32 s16, s32, s33
  s_and_b32 s17, s31, 7
  s_lshr_b32 s32, s30, 2
  s_lshl_b32 s32, s32, 3
  s_lshr_b32 s33, s31, 2
  s_add_u32 s18, s32, s33
  s_and_b32 s32, s30, 3
  s_lshl_b32 s32, s32, 2
  s_and_b32 s33, s31, 3
  s_add_u32 s19, s32, s33
  s_mov_b32 s62, 0x3fb8aa3b
  s_mov_b32 s63, 0x3fb8aa3b
  s_mov_b32 s64, 1.0
  s_mov_b32 s65, 1.0
  s_getpc_b64 s[20:21]
L_pc_anchor:
  s_sub_u32 s20, s20, L_pc_anchor-interleave_layers__linear_kernel_hedgehog__glu_gated_swiglu__prompt_kernel
  s_subb_u32 s21, s21, 0
  s_mov_b32 s8, s20
  s_mov_b32 s9, s21
  s_mov_b32 s10, L_end-interleave_layers__linear_kernel_hedgehog__glu_gated_swiglu__prompt_kernel
  s_mov_b32 s11, 0x20000
  s_lshr_b32 s20, s2, 3
  s_lshl_b32 s20, s20, 11
  buffer_load_dwordx4 v[248:251], v2, s[8:11], s20 offen
  buffer_load_dwordx4 v[252:255], v2, s[8:11], s20 offen offset:1024
  s_barrier
L_prep_s2:
  s_mov_b32 s66, s23
  s_mov_b32 s67, s24
  s_mov_b32 s68, s25
  s_mov_b32 s69, s26
  s_mov_b32 s71, s29
  s_mov_b32 s29, s70
  s_mov_b32 s70, s28
  s_mov_b32 s28, s27
L_prep_end:
  v_and_b32 v40, 15, v1
  v_lshlrev_b32 v40, 1, v40
  v_lshrrev_b32 v41, 5, v1
  v_lshl_add_u32 v40, v41, 7, v40
  v_add_u32 v40, 161792, v40
  ds_read_u16 v216, v40 offset:0
  ds_read_u16 v217, v40 offset:32
  ds_read_u16 v218, v40 offset:64
  ds_read_u16 v219, v40 offset:96
  ds_read_u16 v220, v40 offset:256
  ds_read_u16 v221, v40 offset:288
  ds_read_u16 v222, v40 offset:320
  ds_read_u16 v223, v40 offset:352
  ds_read_u16 v224, v40 offset:512
  ds_read_u16 v225, v40 offset:544
  ds_read_u16 v226, v40 offset:576
  ds_read_u16 v227, v40 offset:608
  ds_read_u16 v228, v40 offset:768
  ds_read_u16 v229, v40 offset:800
  ds_read_u16 v230, v40 offset:832
  s_waitcnt lgkmcnt(14)
  ds_read_u16 v231, v40 offset:864
  v_bfe_u32 v41, v1, 4, 1
  v_cmp_eq_u32 vcc, 0, v41
  s_waitcnt lgkmcnt(14)
  v_lshl_or_b32 v4, v217, 16, v216
  v_cndmask_b32 v4, 0, v4, vcc
  s_waitcnt lgkmcnt(12)
  v_lshl_or_b32 v5, v219, 16, v218
  v_cndmask_b32 v5, 0, v5, vcc
  s_waitcnt lgkmcnt(10)
  v_lshl_or_b32 v6, v221, 16, v220
  v_cndmask_b32 v6, 0, v6, vcc
  s_waitcnt lgkmcnt(8)
  v_lshl_or_b32 v7, v223, 16, v222
  v_cndmask_b32 v7, 0, v7, vcc
  v_cmp_eq_u32 vcc, 1, v41
  s_waitcnt lgkmcnt(6)
  v_lshl_or_b32 v8, v225, 16, v224
  v_cndmask_b32 v8, 0, v8, vcc
  s_waitcnt lgkmcnt(4)
  v_lshl_or_b32 v9, v227, 16, v226
  v_cndmask_b32 v9, 0, v9, vcc
  s_waitcnt lgkmcnt(2)
  v_lshl_or_b32 v10, v229, 16, v228
  v_cndmask_b32 v10, 0, v10, vcc
  s_waitcnt lgkmcnt(0)
  v_lshl_or_b32 v11, v231, 16, v230
  v_cndmask_b32 v11, 0, v11, vcc
  s_nop 1
L_layer:
  s_cmp_lg_u32 s13, 0
  s_cbranch_scc1 Lp1a_1
  s_cmp_lg_u32 s12, 0
  s_cbranch_scc1 Lw_2
  v_and_b32 v215, 15, v1
  v_lshlrev_b32 v214, 4, v1
  s_lshl_b32 s36, s14, 4
  v_add_u32 v214, s36, v215
  v_subrev_u32 v215, 16, v1
  v_lshrrev_b32 v216, 3, v215
  v_lshlrev_b32 v216, 6, v216
  v_and_b32 v215, 7, v215
  v_add_u32 v216, v216, v215
  s_lshr_b32 s36, s15, 1
  s_lshl_b32 s36, s36, 3
  v_add_u32 v216, s36, v216
  v_cmp_le_u32 vcc, 16, v1
  s_nop 1
  v_cndmask_b32 v214, v214, v216, vcc
  s_lshl_b32 s36, s17, 3
  s_add_u32 s36, s36, 192
  v_add_u32 v216, s36, v215
  v_cmp_le_u32 vcc, 40, v1
  s_nop 1
  v_cndmask_b32 v214, v214, v216, vcc
  v_lshlrev_b32 v214, 7, v214
  s_lshl_b32 s39, s13, 3
  s_add_u32 s39, s39, 1
  s_mov_b32 s38, 0
  buffer_load_dword v210, v214, s[4:7], 0 offen sc1
  buffer_load_dword v212, v214, s[4:7], 0 offen sc1
Lpoll_3:
  s_waitcnt vmcnt(1)
  v_cmp_gt_u32 vcc, s39, v210
  s_nop 4
  s_cbranch_vccz Lpolld_4
  buffer_load_dword v210, v214, s[4:7], 0 offen sc1
  s_waitcnt vmcnt(1)
  v_cmp_gt_u32 vcc, s39, v212
  s_nop 4
  s_cbranch_vccz Lpolld_4
  buffer_load_dword v212, v214, s[4:7], 0 offen sc1
  s_add_u32 s38, s38, 1
  s_cmp_le_u32 s38, 200000
  s_cbranch_scc1 Lpoll_3
Lpolld_4:
Lw_2:
  s_barrier
  s_mul_i32 s20, s15, 101376
  s_add_u32 s20, s20, 1048576
  s_cmp_eq_u32 s12, 0
  s_cbranch_scc1 Lw_5
  s_sub_u32 s21, s12, 1
  s_mul_i32 s21, s21, 6
  s_add_u32 s21, s21, 0
  s_min_u32 s21, s21, 10
  s_add_u32 s22, s21, 0
  s_lshr_b32 s23, s22, 3
  s_mul_i32 s23, s23, 33792
  s_and_b32 s24, s22, 7
  s_lshl_b32 s24, s24, 12
  s_add_u32 s23, s23, s24
  s_add_u32 s23, s23, s20
  s_lshl_b32 s24, s22, 12
  s_add_u32 m0, s24, 0
  s_nop 0
  buffer_load_dwordx4 v2, s[4:7], s23 offen offset:0 sc1 lds
  buffer_load_dwordx4 v2, s[4:7], s23 offen offset:1024 sc1 lds
  buffer_load_dwordx4 v2, s[4:7], s23 offen offset:2048 sc1 lds
  buffer_load_dwordx4 v2, s[4:7], s23 offen offset:3072 sc1 lds
  s_add_u32 s22, s21, 1
  s_lshr_b32 s23, s22, 3
  s_mul_i32 s23, s23, 33792
  s_and_b32 s24, s22, 7
  s_lshl_b32 s24, s24, 12
  s_add_u32 s23, s23, s24
  s_add_u32 s23, s23, s20
  s_lshl_b32 s24, s22, 12
  s_add_u32 m0, s24, 0
  s_nop 0
  buffer_load_dwordx4 v2, s[4:7], s23 offen offset:0 sc1 lds
  buffer_load_dwordx4 v2, s[4:7], s23 offen offset:1024 sc1 lds
  buffer_load_dwordx4 v2, s[4:7], s23 offen offset:2048 sc1 lds
  buffer_load_dwordx4 v2, s[4:7], s23 offen offset:3072 sc1 lds
  s_add_u32 s22, s21, 2
  s_lshr_b32 s23, s22, 3
  s_mul_i32 s23, s23, 33792
  s_and_b32 s24, s22, 7
  s_lshl_b32 s24, s24, 12
  s_add_u32 s23, s23, s24
  s_add_u32 s23, s23, s20
  s_lshl_b32 s24, s22, 12
  s_add_u32 m0, s24, 0
  s_nop 0
  buffer_load_dwordx4 v2, s[4:7], s23 offen offset:0 sc1 lds
  buffer_load_dwordx4 v2, s[4:7], s23 offen offset:1024 sc1 lds
  buffer_load_dwordx4 v2, s[4:7], s23 offen offset:2048 sc1 lds
  buffer_load_dwordx4 v2, s[4:7], s23 offen offset:3072 sc1 lds
  s_add_u32 s22, s21, 3
  s_lshr_b32 s23, s22, 3
  s_mul_i32 s23, s23, 33792
  s_and_b32 s24, s22, 7
  s_lshl_b32 s24, s24, 12
  s_add_u32 s23, s23, s24
  s_add_u32 s23, s23, s20
  s_lshl_b32 s24, s22, 12
  s_add_u32 m0, s24, 0
  s_nop 0
  buffer_load_dwordx4 v2, s[4:7], s23 offen offset:0 sc1 lds
  buffer_load_dwordx4 v2, s[4:7], s23 offen offset:1024 sc1 lds
  buffer_load_dwordx4 v2, s[4:7], s23 offen offset:2048 sc1 lds
  buffer_load_dwordx4 v2, s[4:7], s23 offen offset:3072 sc1 lds
  s_add_u32 s22, s21, 4
  s_lshr_b32 s23, s22, 3
  s_mul_i32 s23, s23, 33792
  s_and_b32 s24, s22, 7
  s_lshl_b32 s24, s24, 12
  s_add_u32 s23, s23, s24
  s_add_u32 s23, s23, s20
  s_lshl_b32 s24, s22, 12
  s_add_u32 m0, s24, 0
  s_nop 0
  buffer_load_dwordx4 v2, s[4:7], s23 offen offset:0 sc1 lds
  buffer_load_dwordx4 v2, s[4:7], s23 offen offset:1024 sc1 lds
  buffer_load_dwordx4 v2, s[4:7], s23 offen offset:2048 sc1 lds
  buffer_load_dwordx4 v2, s[4:7], s23 offen offset:3072 sc1 lds
  s_add_u32 s22, s21, 5
  s_lshr_b32 s23, s22, 3
  s_mul_i32 s23, s23, 33792
  s_and_b32 s24, s22, 7
  s_lshl_b32 s24, s24, 12
  s_add_u32 s23, s23, s24
  s_add_u32 s23, s23, s20
  s_lshl_b32 s24, s22, 12
  s_add_u32 m0, s24, 0
  s_nop 0
  buffer_load_dwordx4 v2, s[4:7], s23 offen offset:0 sc1 lds
  buffer_load_dwordx4 v2, s[4:7], s23 offen offset:1024 sc1 lds
  buffer_load_dwordx4 v2, s[4:7], s23 offen offset:2048 sc1 lds
  buffer_load_dwordx4 v2, s[4:7], s23 offen offset:3072 sc1 lds
Lw_5:
Lp1a_1:
  s_mul_i32 s20, s15, 101376
  s_add_u32 s20, s20, 1048576
  s_add_u32 s22, s20, 32768
  buffer_load_dwordx4 v[24:27], v2, s[4:7], s22 offen offset:0 sc1
  s_add_u32 s22, s20, 66560
  buffer_load_dwordx4 v[28:31], v2, s[4:7], s22 offen offset:0 sc1
  s_add_u32 s22, s20, 100352
  buffer_load_dwordx4 v[32:35], v2, s[4:7], s22 offen offset:0 sc1
  s_cmp_eq_u32 s13, 0
  s_cbranch_scc1 Lp1b_6
  s_cmp_lg_u32 s12, 0
  s_cbranch_scc1 Lw_7
  v_and_b32 v215, 15, v1
  s_lshl_b32 s36, s14, 1
  v_lshrrev_b32 v214, 3, v215
  v_add_u32 v214, s36, v214
  v_and_b32 v215, 7, v215
  v_lshlrev_b32 v215, 3, v215
  v_and_b32 v216, 3, v214
  v_lshl_add_u32 v215, v216, 6, v215
  v_lshrrev_b32 v214, 2, v214
  v_add_u32 v214, v214, v215
  v_lshlrev_b32 v214, 7, v214
  s_lshl_b32 s39, s13, 3
  s_add_u32 s39, s39, 0
  s_mov_b32 s38, 0
  buffer_load_dword v210, v214, s[4:7], 0 offen sc1
  buffer_load_dword v212, v214, s[4:7], 0 offen sc1
Lpoll_8:
  s_waitcnt vmcnt(1)
  v_cmp_gt_u32 vcc, s39, v210
  s_nop 4
  s_cbranch_vccz Lpolld_9
  buffer_load_dword v210, v214, s[4:7], 0 offen sc1
  s_waitcnt vmcnt(1)
  v_cmp_gt_u32 vcc, s39, v212
  s_nop 4
  s_cbranch_vccz Lpolld_9
  buffer_load_dword v212, v214, s[4:7], 0 offen sc1
  s_add_u32 s38, s38, 1
  s_cmp_le_u32 s38, 200000
  s_cbranch_scc1 Lpoll_8
Lpolld_9:
Lw_7:
  s_barrier
Lp1b_6:
  s_lshl_b32 s23, s14, 2
  s_add_u32 s23, s23, s12
  s_cmp_eq_u32 s13, 0
  s_mov_b32 s24, 0xe00000
  s_cselect_b32 s24, 0xa00000, s24
  s_lshl_b32 s25, s23, 15
  s_add_u32 s24, s24, s25
  buffer_load_dwordx4 a[0:3], v2, s[4:7], s24 offen offset:0 sc1
  buffer_load_dwordx4 a[4:7], v2, s[4:7], s24 offen offset:1024 sc1
  buffer_load_dwordx4 a[8:11], v2, s[4:7], s24 offen offset:2048 sc1
  buffer_load_dwordx4 a[12:15], v2, s[4:7], s24 offen offset:3072 sc1
  s_add_u32 s24, s24, 4096
  buffer_load_dwordx4 a[16:19], v2, s[4:7], s24 offen offset:0 sc1
  buffer_load_dwordx4 a[20:23], v2, s[4:7], s24 offen offset:1024 sc1
  buffer_load_dwordx4 a[24:27], v2, s[4:7], s24 offen offset:2048 sc1
  buffer_load_dwordx4 a[28:31], v2, s[4:7], s24 offen offset:3072 sc1
  s_add_u32 s24, s24, 4096
  buffer_load_dwordx4 a[32:35], v2, s[4:7], s24 offen offset:0 sc1
  buffer_load_dwordx4 a[36:39], v2, s[4:7], s24 offen offset:1024 sc1
  s_cmp_eq_u32 s13, 0
  s_mov_b32 s27, 0x1280000
  s_cselect_b32 s27, 0x1200000, s27
  s_lshl_b32 s25, s23, 12
  s_add_u32 s27, s27, s25
  v_lshrrev_b32 v15, 5, v1
  v_lshlrev_b32 v15, 11, v15
  v_and_b32 v14, 31, v1
  v_lshl_add_u32 v15, v14, 3, v15
  buffer_load_dwordx2 v[180:181], v15, s[4:7], s27 offen offset:0 sc1
  buffer_load_dwordx2 v[182:183], v15, s[4:7], s27 offen offset:256 sc1
  buffer_load_dwordx2 v[184:185], v15, s[4:7], s27 offen offset:512 sc1
  buffer_load_dwordx2 v[186:187], v15, s[4:7], s27 offen offset:768 sc1
  buffer_load_dwordx2 v[188:189], v15, s[4:7], s27 offen offset:1024 sc1
  buffer_load_dwordx2 v[190:191], v15, s[4:7], s27 offen offset:1280 sc1
  buffer_load_dwordx2 v[192:193], v15, s[4:7], s27 offen offset:1536 sc1
  buffer_load_dwordx2 v[194:195], v15, s[4:7], s27 offen offset:1792 sc1
  s_waitcnt vmcnt(21)
  s_barrier
  ds_read_b128 v[148:151], v2 offset:0
  ds_read_b128 v[152:155], v2 offset:32768
  ds_read_b128 v[156:159], v2 offset:1024
  ds_read_b128 v[160:163], v2 offset:33792
  ds_read_b128 v[164:167], v2 offset:2048
  ds_read_b128 v[168:171], v2 offset:34816
  s_waitcnt lgkmcnt(4)
  s_waitcnt vmcnt(17)
  v_mfma_f32_32x32x16_bf16 v[36:51], v[148:151], a[0:3], 0
  ds_read_b128 v[172:175], v2 offset:3072
  v_mfma_f32_32x32x16_bf16 v[52:67], v[152:155], a[0:3], 0
  ds_read_b128 v[176:179], v2 offset:35840
  buffer_load_dwordx4 a[40:43], v2, s[4:7], s24 offen offset:2048 sc1
  s_waitcnt lgkmcnt(4)
  s_waitcnt vmcnt(17)
  v_mfma_f32_32x32x16_bf16 v[36:51], v[156:159], a[4:7], v[36:51]
  ds_read_b128 v[148:151], v2 offset:4096
  v_mfma_f32_32x32x16_bf16 v[52:67], v[160:163], a[4:7], v[52:67]
  ds_read_b128 v[152:155], v2 offset:36864
  buffer_load_dwordx4 a[44:47], v2, s[4:7], s24 offen offset:3072 sc1
  s_waitcnt lgkmcnt(4)
  s_waitcnt vmcnt(17)
  v_mfma_f32_32x32x16_bf16 v[36:51], v[164:167], a[8:11], v[36:51]
  ds_read_b128 v[156:159], v2 offset:5120
  v_mfma_f32_32x32x16_bf16 v[52:67], v[168:171], a[8:11], v[52:67]
  ds_read_b128 v[160:163], v2 offset:37888
  s_add_u32 s24, s24, 4096
  buffer_load_dwordx4 a[48:51], v2, s[4:7], s24 offen offset:0 sc1
  s_waitcnt lgkmcnt(4)
  s_waitcnt vmcnt(17)
  v_mfma_f32_32x32x16_bf16 v[36:51], v[172:175], a[12:15], v[36:51]
  ds_read_b128 v[164:167], v2 offset:6144
  v_mfma_f32_32x32x16_bf16 v[52:67], v[176:179], a[12:15], v[52:67]
  ds_read_b128 v[168:171], v2 offset:38912
  buffer_load_dwordx4 a[52:55], v2, s[4:7], s24 offen offset:1024 sc1
  s_waitcnt lgkmcnt(4)
  s_waitcnt vmcnt(17)
  v_mfma_f32_32x32x16_bf16 v[36:51], v[148:151], a[16:19], v[36:51]
  ds_read_b128 v[172:175], v2 offset:7168
  v_mfma_f32_32x32x16_bf16 v[52:67], v[152:155], a[16:19], v[52:67]
  ds_read_b128 v[176:179], v2 offset:39936
  buffer_load_dwordx4 a[56:59], v2, s[4:7], s24 offen offset:2048 sc1
  s_waitcnt lgkmcnt(4)
  s_waitcnt vmcnt(17)
  v_mfma_f32_32x32x16_bf16 v[36:51], v[156:159], a[20:23], v[36:51]
  ds_read_b128 v[148:151], v2 offset:8192
  v_mfma_f32_32x32x16_bf16 v[52:67], v[160:163], a[20:23], v[52:67]
  ds_read_b128 v[152:155], v2 offset:40960
  buffer_load_dwordx4 a[60:63], v2, s[4:7], s24 offen offset:3072 sc1
  s_waitcnt lgkmcnt(4)
  s_waitcnt vmcnt(17)
  v_mfma_f32_32x32x16_bf16 v[36:51], v[164:167], a[24:27], v[36:51]
  ds_read_b128 v[156:159], v2 offset:9216
  v_mfma_f32_32x32x16_bf16 v[52:67], v[168:171], a[24:27], v[52:67]
  ds_read_b128 v[160:163], v2 offset:41984
  s_add_u32 s24, s24, 4096
  buffer_load_dwordx4 a[64:67], v2, s[4:7], s24 offen offset:0 sc1
  s_waitcnt lgkmcnt(4)
  s_waitcnt vmcnt(17)
  v_mfma_f32_32x32x16_bf16 v[36:51], v[172:175], a[28:31], v[36:51]
  ds_read_b128 v[164:167], v2 offset:10240
  v_mfma_f32_32x32x16_bf16 v[52:67], v[176:179], a[28:31], v[52:67]
  ds_read_b128 v[168:171], v2 offset:43008
  buffer_load_dwordx4 a[68:71], v2, s[4:7], s24 offen offset:1024 sc1
  s_waitcnt lgkmcnt(4)
  s_waitcnt vmcnt(17)
  v_mfma_f32_32x32x16_bf16 v[36:51], v[148:151], a[32:35], v[36:51]
  ds_read_b128 v[172:175], v2 offset:11264
  v_mfma_f32_32x32x16_bf16 v[52:67], v[152:155], a[32:35], v[52:67]
  ds_read_b128 v[176:179], v2 offset:44032
  buffer_load_dwordx4 a[72:75], v2, s[4:7], s24 offen offset:2048 sc1
  s_waitcnt lgkmcnt(4)
  s_waitcnt vmcnt(17)
  v_mfma_f32_32x32x16_bf16 v[36:51], v[156:159], a[36:39], v[36:51]
  ds_read_b128 v[148:151], v2 offset:12288
  v_mfma_f32_32x32x16_bf16 v[52:67], v[160:163], a[36:39], v[52:67]
  ds_read_b128 v[152:155], v2 offset:45056
  buffer_load_dwordx4 a[76:79], v2, s[4:7], s24 offen offset:3072 sc1
  s_waitcnt lgkmcnt(4)
  s_waitcnt vmcnt(9)
  v_mfma_f32_32x32x16_bf16 v[36:51], v[164:167], a[40:43], v[36:51]
  ds_read_b128 v[156:159], v2 offset:13312
  v_add_f32 v180, v180, v182
  v_mfma_f32_32x32x16_bf16 v[52:67], v[168:171], a[40:43], v[52:67]
  ds_read_b128 v[160:163], v2 offset:46080
  s_add_u32 s24, s24, 4096
  buffer_load_dwordx4 a[80:83], v2, s[4:7], s24 offen offset:0 sc1
  s_waitcnt lgkmcnt(4)
  s_waitcnt vmcnt(9)
  v_mfma_f32_32x32x16_bf16 v[36:51], v[172:175], a[44:47], v[36:51]
  ds_read_b128 v[164:167], v2 offset:14336
  v_add_f32 v181, v181, v183
  v_add_f32 v180, v180, v184
  v_mfma_f32_32x32x16_bf16 v[52:67], v[176:179], a[44:47], v[52:67]
  ds_read_b128 v[168:171], v2 offset:47104
  buffer_load_dwordx4 a[84:87], v2, s[4:7], s24 offen offset:1024 sc1
  s_waitcnt lgkmcnt(4)
  s_waitcnt vmcnt(9)
  v_mfma_f32_32x32x16_bf16 v[36:51], v[148:151], a[48:51], v[36:51]
  ds_read_b128 v[172:175], v2 offset:15360
  v_add_f32 v181, v181, v185
  v_add_f32 v180, v180, v186
  v_mfma_f32_32x32x16_bf16 v[52:67], v[152:155], a[48:51], v[52:67]
  ds_read_b128 v[176:179], v2 offset:48128
  buffer_load_dwordx4 a[88:91], v2, s[4:7], s24 offen offset:2048 sc1
  s_waitcnt lgkmcnt(4)
  s_waitcnt vmcnt(9)
  v_mfma_f32_32x32x16_bf16 v[36:51], v[156:159], a[52:55], v[36:51]
  ds_read_b128 v[148:151], v2 offset:16384
  v_add_f32 v181, v181, v187
  v_mfma_f32_32x32x16_bf16 v[52:67], v[160:163], a[52:55], v[52:67]
  ds_read_b128 v[152:155], v2 offset:49152
  buffer_load_dwordx4 a[92:95], v2, s[4:7], s24 offen offset:3072 sc1
  s_waitcnt lgkmcnt(4)
  s_waitcnt vmcnt(9)
  v_mfma_f32_32x32x16_bf16 v[36:51], v[164:167], a[56:59], v[36:51]
  ds_read_b128 v[156:159], v2 offset:17408
  v_add_f32 v180, v180, v188
  v_add_f32 v181, v181, v189
  v_mfma_f32_32x32x16_bf16 v[52:67], v[168:171], a[56:59], v[52:67]
  ds_read_b128 v[160:163], v2 offset:50176
  s_add_u32 s24, s24, 4096
  buffer_load_dwordx4 a[96:99], v2, s[4:7], s24 offen offset:0 sc1
  s_waitcnt lgkmcnt(4)
  s_waitcnt vmcnt(9)
  v_mfma_f32_32x32x16_bf16 v[36:51], v[172:175], a[60:63], v[36:51]
  ds_read_b128 v[164:167], v2 offset:18432
  v_add_f32 v180, v180, v190
  v_mfma_f32_32x32x16_bf16 v[52:67], v[176:179], a[60:63], v[52:67]
  ds_read_b128 v[168:171], v2 offset:51200
  buffer_load_dwordx4 a[100:103], v2, s[4:7], s24 offen offset:1024 sc1
  s_waitcnt lgkmcnt(4)
  s_waitcnt vmcnt(9)
  v_mfma_f32_32x32x16_bf16 v[36:51], v[148:151], a[64:67], v[36:51]
  ds_read_b128 v[172:175], v2 offset:19456
  v_add_f32 v181, v181, v191
  v_add_f32 v180, v180, v192
  v_mfma_f32_32x32x16_bf16 v[52:67], v[152:155], a[64:67], v[52:67]
  ds_read_b128 v[176:179], v2 offset:52224
  buffer_load_dwordx4 a[104:107], v2, s[4:7], s24 offen offset:2048 sc1
  s_waitcnt lgkmcnt(4)
  s_waitcnt vmcnt(9)
  v_mfma_f32_32x32x16_bf16 v[36:51], v[156:159], a[68:71], v[36:51]
  ds_read_b128 v[148:151], v2 offset:20480
  v_add_f32 v181, v181, v193
  v_mfma_f32_32x32x16_bf16 v[52:67], v[160:163], a[68:71], v[52:67]
  ds_read_b128 v[152:155], v2 offset:53248
  buffer_load_dwordx4 a[108:111], v2, s[4:7], s24 offen offset:3072 sc1
  s_waitcnt lgkmcnt(4)
  s_waitcnt vmcnt(9)
  v_mfma_f32_32x32x16_bf16 v[36:51], v[164:167], a[72:75], v[36:51]
  ds_read_b128 v[156:159], v2 offset:21504
  v_add_f32 v180, v180, v194
  v_add_f32 v181, v181, v195
  v_mfma_f32_32x32x16_bf16 v[52:67], v[168:171], a[72:75], v[52:67]
  ds_read_b128 v[160:163], v2 offset:54272
  s_add_u32 s24, s24, 4096
  buffer_load_dwordx4 a[112:115], v2, s[4:7], s24 offen offset:0 sc1
  s_waitcnt lgkmcnt(4)
  s_waitcnt vmcnt(9)
  v_mfma_f32_32x32x16_bf16 v[36:51], v[172:175], a[76:79], v[36:51]
  ds_read_b128 v[164:167], v2 offset:22528
  v_mov_b32 v182, v180
  v_mfma_f32_32x32x16_bf16 v[52:67], v[176:179], a[76:79], v[52:67]
  ds_read_b128 v[168:171], v2 offset:55296
  buffer_load_dwordx4 a[116:119], v2, s[4:7], s24 offen offset:1024 sc1
  s_waitcnt lgkmcnt(4)
  v_mov_b32 v183, v181
  s_waitcnt vmcnt(9)
  v_mfma_f32_32x32x16_bf16 v[36:51], v[148:151], a[80:83], v[36:51]
  ds_read_b128 v[172:175], v2 offset:23552
  v_permlane32_swap_b32 v180, v182
  v_mfma_f32_32x32x16_bf16 v[52:67], v[152:155], a[80:83], v[52:67]
  ds_read_b128 v[176:179], v2 offset:56320
  buffer_load_dwordx4 a[120:123], v2, s[4:7], s24 offen offset:2048 sc1
  s_waitcnt lgkmcnt(4)
  s_waitcnt vmcnt(9)
  v_mfma_f32_32x32x16_bf16 v[36:51], v[156:159], a[84:87], v[36:51]
  ds_read_b128 v[148:151], v2 offset:24576
  v_mfma_f32_32x32x16_bf16 v[52:67], v[160:163], a[84:87], v[52:67]
  ds_read_b128 v[152:155], v2 offset:57344
  buffer_load_dwordx4 a[124:127], v2, s[4:7], s24 offen offset:3072 sc1
  s_waitcnt lgkmcnt(4)
  s_waitcnt vmcnt(9)
  v_mfma_f32_32x32x16_bf16 v[36:51], v[164:167], a[88:91], v[36:51]
  ds_read_b128 v[156:159], v2 offset:25600
  v_permlane32_swap_b32 v181, v183
  v_mfma_f32_32x32x16_bf16 v[52:67], v[168:171], a[88:91], v[52:67]
  ds_read_b128 v[160:163], v2 offset:58368
  s_waitcnt lgkmcnt(4)
  v_add_f32 v180, v180, v182
  v_add_f32 v181, v181, v183
  s_waitcnt vmcnt(8)
  v_mfma_f32_32x32x16_bf16 v[36:51], v[172:175], a[92:95], v[36:51]
  ds_read_b128 v[164:167], v2 offset:26624
  v_mul_f32 v180, 0x3b000000, v180
  v_mfma_f32_32x32x16_bf16 v[52:67], v[176:179], a[92:95], v[52:67]
  ds_read_b128 v[168:171], v2 offset:59392
  s_waitcnt lgkmcnt(4)
  v_mul_f32 v181, 0x3b000000, v181
  s_waitcnt vmcnt(7)
  v_mfma_f32_32x32x16_bf16 v[36:51], v[148:151], a[96:99], v[36:51]
  ds_read_b128 v[172:175], v2 offset:27648
  v_fma_f32 v181, -v180, v180, v181
  v_max_f32 v181, 0, v181
  v_mfma_f32_32x32x16_bf16 v[52:67], v[152:155], a[96:99], v[52:67]
  ds_read_b128 v[176:179], v2 offset:60416
  s_waitcnt lgkmcnt(4)
  v_add_f32 v181, 0x3727c5ac, v181
  s_waitcnt vmcnt(6)
  v_mfma_f32_32x32x16_bf16 v[36:51], v[156:159], a[100:103], v[36:51]
  ds_read_b128 v[148:151], v2 offset:28672
  v_rsq_f32 v12, v181
  v_mfma_f32_32x32x16_bf16 v[52:67], v[160:163], a[100:103], v[52:67]
  ds_read_b128 v[152:155], v2 offset:61440
  s_waitcnt lgkmcnt(4)
  v_sub_f32 v180, 0, v180
  s_waitcnt vmcnt(5)
  v_mfma_f32_32x32x16_bf16 v[36:51], v[164:167], a[104:107], v[36:51]
  ds_read_b128 v[156:159], v2 offset:29696
  v_cvt_pk_bf16_f32 v16, v180, v180
  v_mfma_f32_32x32x16_bf16 v[52:67], v[168:171], a[104:107], v[52:67]
  ds_read_b128 v[160:163], v2 offset:62464
  s_waitcnt lgkmcnt(4)
  v_mov_b32 v17, v16
  s_waitcnt vmcnt(4)
  v_mfma_f32_32x32x16_bf16 v[36:51], v[172:175], a[108:111], v[36:51]
  ds_read_b128 v[164:167], v2 offset:30720
  v_mov_b32 v18, v16
  v_mov_b32 v19, v16
  v_mfma_f32_32x32x16_bf16 v[52:67], v[176:179], a[108:111], v[52:67]
  ds_read_b128 v[168:171], v2 offset:63488
  s_waitcnt lgkmcnt(4)
  s_waitcnt vmcnt(3)
  v_mfma_f32_32x32x16_bf16 v[36:51], v[148:151], a[112:115], v[36:51]
  ds_read_b128 v[172:175], v2 offset:31744
  v_mfma_f32_32x32x16_bf16 v[52:67], v[152:155], a[112:115], v[52:67]
  ds_read_b128 v[176:179], v2 offset:64512
  s_waitcnt vmcnt(2) lgkmcnt(5)
  v_mfma_f32_32x32x16_bf16 v[36:51], v[156:159], a[116:119], v[36:51]
  s_waitcnt lgkmcnt(4)
  v_mfma_f32_32x32x16_bf16 v[52:67], v[160:163], a[116:119], v[52:67]
  s_waitcnt vmcnt(1) lgkmcnt(3)
  v_mfma_f32_32x32x16_bf16 v[36:51], v[164:167], a[120:123], v[36:51]
  s_waitcnt lgkmcnt(2)
  v_mfma_f32_32x32x16_bf16 v[52:67], v[168:171], a[120:123], v[52:67]
  s_waitcnt vmcnt(0) lgkmcnt(1)
  v_mfma_f32_32x32x16_bf16 v[36:51], v[172:175], a[124:127], v[36:51]
  s_waitcnt lgkmcnt(0)
  v_mfma_f32_32x32x16_bf16 v[52:67], v[176:179], a[124:127], v[52:67]
  v_mfma_f32_32x32x16_bf16 v[36:51], v[24:27], v[16:19], v[36:51]
  v_mfma_f32_32x32x16_bf16 v[52:67], v[28:31], v[16:19], v[52:67]
  s_cmp_lg_u32 s13, 0
  s_nop 10
  s_cbranch_scc1 Lp1h_10
  s_cmp_lg_u32 s12, 0
  s_cbranch_scc1 Lw_11
  s_mul_i32 s22, s15, 101376
  s_add_u32 s22, s22, 1116160
  s_mov_b32 m0, 65536
  s_nop 0
  buffer_load_dwordx4 v2, s[4:7], s22 offen offset:0 sc1 lds
  buffer_load_dwordx4 v2, s[4:7], s22 offen offset:1024 sc1 lds
  buffer_load_dwordx4 v2, s[4:7], s22 offen offset:2048 sc1 lds
  buffer_load_dwordx4 v2, s[4:7], s22 offen offset:3072 sc1 lds
  s_mov_b32 m0, 69632
  s_add_u32 s22, s22, 4096
  buffer_load_dwordx4 v2, s[4:7], s22 offen offset:0 sc1 lds
  buffer_load_dwordx4 v2, s[4:7], s22 offen offset:1024 sc1 lds
  buffer_load_dwordx4 v2, s[4:7], s22 offen offset:2048 sc1 lds
  buffer_load_dwordx4 v2, s[4:7], s22 offen offset:3072 sc1 lds
  s_mov_b32 m0, 73728
  s_add_u32 s22, s22, 4096
  buffer_load_dwordx4 v2, s[4:7], s22 offen offset:0 sc1 lds
  buffer_load_dwordx4 v2, s[4:7], s22 offen offset:1024 sc1 lds
  buffer_load_dwordx4 v2, s[4:7], s22 offen offset:2048 sc1 lds
  buffer_load_dwordx4 v2, s[4:7], s22 offen offset:3072 sc1 lds
  s_mov_b32 m0, 77824
  s_add_u32 s22, s22, 4096
  buffer_load_dwordx4 v2, s[4:7], s22 offen offset:0 sc1 lds
  buffer_load_dwordx4 v2, s[4:7], s22 offen offset:1024 sc1 lds
  buffer_load_dwordx4 v2, s[4:7], s22 offen offset:2048 sc1 lds
  buffer_load_dwordx4 v2, s[4:7], s22 offen offset:3072 sc1 lds
  s_mov_b32 m0, 81920
  s_add_u32 s22, s22, 4096
  buffer_load_dwordx4 v2, s[4:7], s22 offen offset:0 sc1 lds
  buffer_load_dwordx4 v2, s[4:7], s22 offen offset:1024 sc1 lds
  buffer_load_dwordx4 v2, s[4:7], s22 offen offset:2048 sc1 lds
  buffer_load_dwordx4 v2, s[4:7], s22 offen offset:3072 sc1 lds
  s_mov_b32 m0, 86016
  s_add_u32 s22, s22, 4096
  buffer_load_dwordx4 v2, s[4:7], s22 offen offset:0 sc1 lds
  buffer_load_dwordx4 v2, s[4:7], s22 offen offset:1024 sc1 lds
  buffer_load_dwordx4 v2, s[4:7], s22 offen offset:2048 sc1 lds
  buffer_load_dwordx4 v2, s[4:7], s22 offen offset:3072 sc1 lds
  s_mov_b32 m0, 90112
  s_add_u32 s22, s22, 4096
  buffer_load_dwordx4 v2, s[4:7], s22 offen offset:0 sc1 lds
  buffer_load_dwordx4 v2, s[4:7], s22 offen offset:1024 sc1 lds
  buffer_load_dwordx4 v2, s[4:7], s22 offen offset:2048 sc1 lds
  buffer_load_dwordx4 v2, s[4:7], s22 offen offset:3072 sc1 lds
  s_mov_b32 m0, 94208
  s_add_u32 s22, s22, 4096
  buffer_load_dwordx4 v2, s[4:7], s22 offen offset:0 sc1 lds
  buffer_load_dwordx4 v2, s[4:7], s22 offen offset:1024 sc1 lds
  buffer_load_dwordx4 v2, s[4:7], s22 offen offset:2048 sc1 lds
  buffer_load_dwordx4 v2, s[4:7], s22 offen offset:3072 sc1 lds
Lw_11:
  s_cmp_eq_u32 s12, 0
  s_cbranch_scc1 Lw_12
  v_and_b32 v20, 15, v1
  v_bfe_u32 v21, v1, 4, 1
  v_lshrrev_b32 v22, 5, v1
  v_bfe_u32 v24, v1, 2, 2
  v_lshl_add_u32 v24, v22, 2, v24
  v_lshlrev_b32 v24, 7, v24
  v_lshl_add_u32 v24, v21, 5, v24
  v_and_b32 v25, 3, v1
  v_lshl_add_u32 v24, v25, 3, v24
  v_add_u32 v24, s29, v24
  ds_read_b64_tr_b16 v[100:101], v24 offset:0
  ds_read_b64_tr_b16 v[102:103], v24 offset:1024
  ds_read_b64_tr_b16 v[104:105], v24 offset:64
  ds_read_b64_tr_b16 v[106:107], v24 offset:1088
  ds_read_b64_tr_b16 v[108:109], v24 offset:2048
  ds_read_b64_tr_b16 v[110:111], v24 offset:3072
  ds_read_b64_tr_b16 v[112:113], v24 offset:2112
  ds_read_b64_tr_b16 v[114:115], v24 offset:3136
  ds_read_b64_tr_b16 v[116:117], v24 offset:4096
  ds_read_b64_tr_b16 v[118:119], v24 offset:5120
  ds_read_b64_tr_b16 v[120:121], v24 offset:4160
  ds_read_b64_tr_b16 v[122:123], v24 offset:5184
  ds_read_b64_tr_b16 v[124:125], v24 offset:6144
  ds_read_b64_tr_b16 v[126:127], v24 offset:7168
  ds_read_b64_tr_b16 v[128:129], v24 offset:6208
  s_waitcnt lgkmcnt(14)
  ds_read_b64_tr_b16 v[130:131], v24 offset:7232
  v_and_b32 v134, 31, v1
  v_lshlrev_b32 v134, 4, v134
  s_cmp_eq_u32 s28, 0
  s_nop 0
  s_cbranch_scc1 L_up_plain_s2
  v_lshrrev_b32 v25, 3, v20
  v_lshlrev_b32 v25, 4, v25
  v_and_b32 v134, 7, v20
  v_add_u32 v134, v134, v25
  s_sub_u32 s38, s28, 1
  s_lshl_b32 s38, s38, 3
  v_add_u32 v134, s38, v134
  v_lshlrev_b32 v134, 4, v134
  s_mov_b32 s38, 33792
  v_mul_lo_u32 v25, v21, s38
  v_add_u32 v134, v134, v25
  s_nop 1
L_up_plain_s2:
  v_lshl_add_u32 v135, v22, 9, v134
  v_mov_b32 v28, 0
  v_mov_b32 v29, 0
  v_dot2c_f32_bf16 v28, 0x3f803f80, v100
  s_waitcnt lgkmcnt(13)
  v_dot2c_f32_bf16 v29, 0x3f803f80, v104
  v_dot2c_f32_bf16 v28, 0x3f803f80, v101
  v_dot2c_f32_bf16 v29, 0x3f803f80, v105
  v_dot2c_f32_bf16 v28, 0x3f803f80, v102
  s_waitcnt lgkmcnt(12)
  v_dot2c_f32_bf16 v29, 0x3f803f80, v106
  v_dot2c_f32_bf16 v28, 0x3f803f80, v103
  v_dot2c_f32_bf16 v29, 0x3f803f80, v107
  s_waitcnt lgkmcnt(11)
  v_dot2c_f32_bf16 v28, 0x3f803f80, v108
  s_waitcnt lgkmcnt(9)
  v_dot2c_f32_bf16 v29, 0x3f803f80, v112
  v_dot2c_f32_bf16 v28, 0x3f803f80, v109
  v_dot2c_f32_bf16 v29, 0x3f803f80, v113
  v_dot2c_f32_bf16 v28, 0x3f803f80, v110
  s_waitcnt lgkmcnt(8)
  v_dot2c_f32_bf16 v29, 0x3f803f80, v114
  v_dot2c_f32_bf16 v28, 0x3f803f80, v111
  v_dot2c_f32_bf16 v29, 0x3f803f80, v115
  s_waitcnt lgkmcnt(7)
  v_dot2c_f32_bf16 v28, 0x3f803f80, v116
  s_waitcnt lgkmcnt(5)
  v_dot2c_f32_bf16 v29, 0x3f803f80, v120
  v_dot2c_f32_bf16 v28, 0x3f803f80, v117
  v_dot2c_f32_bf16 v29, 0x3f803f80, v121
  v_dot2c_f32_bf16 v28, 0x3f803f80, v118
  s_waitcnt lgkmcnt(4)
  v_dot2c_f32_bf16 v29, 0x3f803f80, v122
  v_dot2c_f32_bf16 v28, 0x3f803f80, v119
  v_dot2c_f32_bf16 v29, 0x3f803f80, v123
  s_waitcnt lgkmcnt(3)
  v_dot2c_f32_bf16 v28, 0x3f803f80, v124
  s_waitcnt lgkmcnt(1)
  v_dot2c_f32_bf16 v29, 0x3f803f80, v128
  v_dot2c_f32_bf16 v28, 0x3f803f80, v125
  v_dot2c_f32_bf16 v29, 0x3f803f80, v129
  v_dot2c_f32_bf16 v28, 0x3f803f80, v126
  s_waitcnt lgkmcnt(0)
  v_dot2c_f32_bf16 v29, 0x3f803f80, v130
  v_dot2c_f32_bf16 v28, 0x3f803f80, v127
  v_dot2c_f32_bf16 v29, 0x3f803f80, v131
  s_nop 1
  v_mov_b32 v30, v28
  s_nop 1
  v_permlane32_swap_b32 v28, v30
  v_add_f32 v28, v28, v30
  v_cvt_pk_bf16_f32 v31, v28, v28
  v_lshlrev_b32 v30, 16, v31
  v_sub_f32 v30, v28, v30
  v_cvt_pk_bf16_f32 v132, v28, v30
  v_mov_b32 v30, v29
  s_nop 1
  v_permlane32_swap_b32 v29, v30
  v_add_f32 v29, v29, v30
  v_cvt_pk_bf16_f32 v31, v29, v29
  v_lshlrev_b32 v30, 16, v31
  v_sub_f32 v30, v29, v30
  v_cvt_pk_bf16_f32 v133, v29, v30
  s_cmp_eq_u32 s69, 0
  s_nop 0
  s_cbranch_scc1 L_us_done_h
  s_mov_b32 s39, s66
  buffer_store_dwordx4 v[100:103], v135, s[4:7], s39 offen sc1
  s_add_u32 s38, s39, s68
  buffer_store_dwordx4 v[104:107], v135, s[4:7], s38 offen sc1
  s_add_u32 s39, s39, s67
  buffer_store_dwordx4 v[108:111], v135, s[4:7], s39 offen sc1
  s_add_u32 s38, s39, s68
  buffer_store_dwordx4 v[112:115], v135, s[4:7], s38 offen sc1
  s_add_u32 s39, s39, s67
  buffer_store_dwordx4 v[116:119], v135, s[4:7], s39 offen sc1
  s_add_u32 s38, s39, s68
  buffer_store_dwordx4 v[120:123], v135, s[4:7], s38 offen sc1
  s_add_u32 s39, s39, s67
  s_cmp_lt_u32 s69, 4
  s_cbranch_scc1 L_us_kb_h
  buffer_store_dwordx4 v[124:127], v135, s[4:7], s39 offen sc1
  s_add_u32 s38, s39, s68
  buffer_store_dwordx4 v[128:131], v135, s[4:7], s38 offen sc1
  s_add_u32 s39, s39, s67
  s_nop 0
L_us_kb_h:
  s_cmp_eq_u32 s70, 0
  s_cbranch_scc1 L_us_done_h
  s_mov_b32 exec_hi, 0
  buffer_store_dword v132, v134, s[4:7], s71 offen sc1
  s_add_u32 s39, s71, s68
  buffer_store_dword v133, v134, s[4:7], s39 offen sc1
  s_mov_b64 exec, -1
L_us_done_h:
Lw_12:
Lp1h_10:
  v_pk_mul_f32 v[36:37], v[36:37], v[12:13] op_sel_hi:[1,0]
  v_pk_mul_f32 v[38:39], v[38:39], v[12:13] op_sel_hi:[1,0]
  v_pk_mul_f32 v[40:41], v[40:41], v[12:13] op_sel_hi:[1,0]
  v_pk_mul_f32 v[42:43], v[42:43], v[12:13] op_sel_hi:[1,0]
  v_pk_mul_f32 v[44:45], v[44:45], v[12:13] op_sel_hi:[1,0]
  v_pk_mul_f32 v[46:47], v[46:47], v[12:13] op_sel_hi:[1,0]
  v_pk_mul_f32 v[48:49], v[48:49], v[12:13] op_sel_hi:[1,0]
  v_pk_mul_f32 v[50:51], v[50:51], v[12:13] op_sel_hi:[1,0]
  v_cvt_pk_bf16_f32 v196, v36, v37
  v_cvt_pk_bf16_f32 v197, v38, v39
  v_cvt_pk_bf16_f32 v198, v40, v41
  v_cvt_pk_bf16_f32 v199, v42, v43
  v_cvt_pk_bf16_f32 v200, v44, v45
  v_cvt_pk_bf16_f32 v201, v46, v47
  v_cvt_pk_bf16_f32 v202, v48, v49
  v_cvt_pk_bf16_f32 v203, v50, v51
  v_mfma_f32_32x32x16_bf16 v[84:99], v[4:7], v[196:199], 0
  s_nop 0
  v_mfma_f32_32x32x16_bf16 v[84:99], v[8:11], v[200:203], v[84:99]
  v_and_b32 v14, 31, v1
  s_lshl_b32 s26, s12, 5
  v_add_u32 v14, s26, v14
  v_bfe_u32 v13, v14, 1, 2
  v_lshlrev_b32 v14, 6, v14
  v_add_u32 v14, 131072, v14
  v_lshrrev_b32 v15, 5, v1
  v_xor_b32 v184, v13, v15
  v_xor_b32 v185, 2, v184
  v_lshl_add_u32 v184, v184, 4, v14
  v_lshl_add_u32 v185, v185, 4, v14
  v_lshl_add_u32 v14, v15, 3, v14
  v_xor_b32 v187, 1, v13
  v_lshl_add_u32 v186, v13, 4, v14
  v_lshl_add_u32 v187, v187, 4, v14
  v_mov_b32 v180, 0x3f803f80
  v_mov_b32 v181, 0x3f803f80
  v_mov_b32 v182, 0x3f803f80
  v_mov_b32 v183, 0x3f803f80
  ds_write_b128 v185, v[180:183] offset:16384
  ds_write_b128 v185, v[180:183] offset:24576
  v_pk_mul_f32 v[52:53], v[52:53], v[12:13] op_sel_hi:[1,0]
  v_pk_mul_f32 v[54:55], v[54:55], v[12:13] op_sel_hi:[1,0]
  v_pk_mul_f32 v[56:57], v[56:57], v[12:13] op_sel_hi:[1,0]
  v_pk_mul_f32 v[58:59], v[58:59], v[12:13] op_sel_hi:[1,0]
  v_pk_mul_f32 v[60:61], v[60:61], v[12:13] op_sel_hi:[1,0]
  v_pk_mul_f32 v[62:63], v[62:63], v[12:13] op_sel_hi:[1,0]
  v_pk_mul_f32 v[64:65], v[64:65], v[12:13] op_sel_hi:[1,0]
  v_pk_mul_f32 v[66:67], v[66:67], v[12:13] op_sel_hi:[1,0]
  v_cvt_pk_bf16_f32 v204, v52, v53
  v_cvt_pk_bf16_f32 v205, v54, v55
  v_cvt_pk_bf16_f32 v206, v56, v57
  v_cvt_pk_bf16_f32 v207, v58, v59
  v_cvt_pk_bf16_f32 v208, v60, v61
  v_cvt_pk_bf16_f32 v209, v62, v63
  v_cvt_pk_bf16_f32 v210, v64, v65
  v_cvt_pk_bf16_f32 v211, v66, v67
  ds_write_b64 v186, v[204:205] offset:16384
  ds_write_b64 v187, v[206:207] offset:16384
  ds_write_b64 v186, v[208:209] offset:24576
  ds_write_b64 v187, v[210:211] offset:24576
  v_max3_f32 v132, v84, v85, v86
  v_min3_f32 v134, v84, v85, v86
  v_max3_f32 v136, v92, v93, v94
  v_min3_f32 v138, v92, v93, v94
  v_max3_f32 v132, v132, v87, v88
  v_min3_f32 v134, v134, v87, v88
  v_max3_f32 v136, v136, v95, v96
  v_min3_f32 v138, v138, v95, v96
  v_max3_f32 v132, v132, v89, v90
  v_min3_f32 v134, v134, v89, v90
  v_max3_f32 v136, v136, v97, v98
  v_min3_f32 v138, v138, v97, v98
  v_max_f32 v132, v132, v91
  v_min_f32 v134, v134, v91
  v_max_f32 v136, v136, v99
  v_min_f32 v138, v138, v99
  v_mov_b32 v140, v132
  v_mov_b32 v141, v134
  v_mov_b32 v142, v136
  v_mov_b32 v143, v138
  v_permlane32_swap_b32 v132, v140
  v_permlane32_swap_b32 v134, v141
  v_permlane32_swap_b32 v136, v142
  v_permlane32_swap_b32 v138, v143
  v_max_f32 v132, v132, v140
  v_min_f32 v134, v134, v141
  v_max_f32 v136, v136, v142
  v_min_f32 v138, v138, v143
  v_mul_f32 v132, s62, v132
  v_mul_f32 v134, s62, v134
  v_mul_f32 v136, s62, v136
  v_mul_f32 v138, s62, v138
  v_pk_fma_f32 v[100:101], v[84:85], s[62:63], v[132:133] op_sel_hi:[1,1,0] neg_lo:[0,0,1] neg_hi:[0,0,1]
  v_pk_fma_f32 v[108:109], v[84:85], s[62:63], v[134:135] op_sel_hi:[1,1,0] neg_lo:[1,0,0] neg_hi:[1,0,0]
  v_pk_fma_f32 v[116:117], v[92:93], s[62:63], v[136:137] op_sel_hi:[1,1,0] neg_lo:[0,0,1] neg_hi:[0,0,1]
  v_pk_fma_f32 v[124:125], v[92:93], s[62:63], v[138:139] op_sel_hi:[1,1,0] neg_lo:[1,0,0] neg_hi:[1,0,0]
  v_pk_fma_f32 v[102:103], v[86:87], s[62:63], v[132:133] op_sel_hi:[1,1,0] neg_lo:[0,0,1] neg_hi:[0,0,1]
  v_pk_fma_f32 v[110:111], v[86:87], s[62:63], v[134:135] op_sel_hi:[1,1,0] neg_lo:[1,0,0] neg_hi:[1,0,0]
  v_pk_fma_f32 v[118:119], v[94:95], s[62:63], v[136:137] op_sel_hi:[1,1,0] neg_lo:[0,0,1] neg_hi:[0,0,1]
  v_pk_fma_f32 v[126:127], v[94:95], s[62:63], v[138:139] op_sel_hi:[1,1,0] neg_lo:[1,0,0] neg_hi:[1,0,0]
  v_pk_fma_f32 v[104:105], v[88:89], s[62:63], v[132:133] op_sel_hi:[1,1,0] neg_lo:[0,0,1] neg_hi:[0,0,1]
  v_pk_fma_f32 v[112:113], v[88:89], s[62:63], v[134:135] op_sel_hi:[1,1,0] neg_lo:[1,0,0] neg_hi:[1,0,0]
  v_pk_fma_f32 v[120:121], v[96:97], s[62:63], v[136:137] op_sel_hi:[1,1,0] neg_lo:[0,0,1] neg_hi:[0,0,1]
  v_pk_fma_f32 v[128:129], v[96:97], s[62:63], v[138:139] op_sel_hi:[1,1,0] neg_lo:[1,0,0] neg_hi:[1,0,0]
  v_pk_fma_f32 v[106:107], v[90:91], s[62:63], v[132:133] op_sel_hi:[1,1,0] neg_lo:[0,0,1] neg_hi:[0,0,1]
  v_pk_fma_f32 v[114:115], v[90:91], s[62:63], v[134:135] op_sel_hi:[1,1,0] neg_lo:[1,0,0] neg_hi:[1,0,0]
  v_pk_fma_f32 v[122:123], v[98:99], s[62:63], v[136:137] op_sel_hi:[1,1,0] neg_lo:[0,0,1] neg_hi:[0,0,1]
  v_pk_fma_f32 v[130:131], v[98:99], s[62:63], v[138:139] op_sel_hi:[1,1,0] neg_lo:[1,0,0] neg_hi:[1,0,0]
  v_exp_f32 v100, v100
  v_exp_f32 v108, v108
  v_exp_f32 v116, v116
  v_exp_f32 v124, v124
  v_exp_f32 v101, v101
  v_exp_f32 v109, v109
  v_exp_f32 v117, v117
  v_exp_f32 v125, v125
  v_exp_f32 v102, v102
  v_exp_f32 v110, v110
  v_exp_f32 v118, v118
  v_exp_f32 v126, v126
  v_exp_f32 v103, v103
  v_exp_f32 v111, v111
  v_exp_f32 v119, v119
  v_exp_f32 v127, v127
  v_exp_f32 v104, v104
  v_exp_f32 v112, v112
  v_exp_f32 v120, v120
  v_exp_f32 v128, v128
  v_exp_f32 v105, v105
  v_exp_f32 v113, v113
  v_exp_f32 v121, v121
  v_exp_f32 v129, v129
  v_exp_f32 v106, v106
  v_exp_f32 v114, v114
  v_exp_f32 v122, v122
  v_exp_f32 v130, v130
  v_exp_f32 v107, v107
  v_exp_f32 v115, v115
  v_exp_f32 v123, v123
  v_exp_f32 v131, v131
  v_pk_add_f32 v[140:141], v[100:101], v[102:103]
  v_pk_add_f32 v[142:143], v[108:109], v[110:111]
  v_pk_add_f32 v[144:145], v[116:117], v[118:119]
  v_pk_add_f32 v[146:147], v[124:125], v[126:127]
  v_pk_add_f32 v[140:141], v[140:141], v[104:105]
  v_pk_add_f32 v[142:143], v[142:143], v[112:113]
  v_pk_add_f32 v[144:145], v[144:145], v[120:121]
  v_pk_add_f32 v[146:147], v[146:147], v[128:129]
  v_pk_add_f32 v[140:141], v[140:141], v[106:107]
  v_pk_add_f32 v[142:143], v[142:143], v[114:115]
  v_pk_add_f32 v[144:145], v[144:145], v[122:123]
  v_pk_add_f32 v[146:147], v[146:147], v[130:131]
  v_add_f32 v140, v140, v141
  v_add_f32 v142, v142, v143
  v_add_f32 v144, v144, v145
  v_add_f32 v146, v146, v147
  v_mov_b32 v141, v140
  v_mov_b32 v143, v142
  v_mov_b32 v145, v144
  v_mov_b32 v147, v146
  v_permlane32_swap_b32 v140, v141
  v_permlane32_swap_b32 v142, v143
  v_permlane32_swap_b32 v144, v145
  v_permlane32_swap_b32 v146, v147
  v_add_f32 v140, v140, v141
  v_add_f32 v142, v142, v143
  v_add_f32 v144, v144, v145
  v_add_f32 v146, v146, v147
  v_rcp_f32 v140, v140
  v_rcp_f32 v142, v142
  v_rcp_f32 v144, v144
  v_rcp_f32 v146, v146
  v_pk_mul_f32 v[100:101], v[100:101], v[140:141] op_sel_hi:[1,0]
  v_pk_mul_f32 v[108:109], v[108:109], v[142:143] op_sel_hi:[1,0]
  v_pk_mul_f32 v[116:117], v[116:117], v[144:145] op_sel_hi:[1,0]
  v_pk_mul_f32 v[124:125], v[124:125], v[146:147] op_sel_hi:[1,0]
  v_pk_mul_f32 v[102:103], v[102:103], v[140:141] op_sel_hi:[1,0]
  v_pk_mul_f32 v[110:111], v[110:111], v[142:143] op_sel_hi:[1,0]
  v_pk_mul_f32 v[118:119], v[118:119], v[144:145] op_sel_hi:[1,0]
  v_pk_mul_f32 v[126:127], v[126:127], v[146:147] op_sel_hi:[1,0]
  v_pk_mul_f32 v[104:105], v[104:105], v[140:141] op_sel_hi:[1,0]
  v_pk_mul_f32 v[112:113], v[112:113], v[142:143] op_sel_hi:[1,0]
  v_pk_mul_f32 v[120:121], v[120:121], v[144:145] op_sel_hi:[1,0]
  v_pk_mul_f32 v[128:129], v[128:129], v[146:147] op_sel_hi:[1,0]
  v_pk_mul_f32 v[106:107], v[106:107], v[140:141] op_sel_hi:[1,0]
  v_pk_mul_f32 v[114:115], v[114:115], v[142:143] op_sel_hi:[1,0]
  v_pk_mul_f32 v[122:123], v[122:123], v[144:145] op_sel_hi:[1,0]
  v_pk_mul_f32 v[130:131], v[130:131], v[146:147] op_sel_hi:[1,0]
  v_cvt_pk_bf16_f32 v84, v100, v101
  v_cvt_pk_bf16_f32 v88, v108, v109
  v_cvt_pk_bf16_f32 v92, v116, v117
  v_cvt_pk_bf16_f32 v96, v124, v125
  v_cvt_pk_bf16_f32 v85, v102, v103
  v_cvt_pk_bf16_f32 v89, v110, v111
  v_cvt_pk_bf16_f32 v93, v118, v119
  v_cvt_pk_bf16_f32 v97, v126, v127
  v_cvt_pk_bf16_f32 v86, v104, v105
  v_cvt_pk_bf16_f32 v90, v112, v113
  v_cvt_pk_bf16_f32 v94, v120, v121
  v_cvt_pk_bf16_f32 v98, v128, v129
  v_cvt_pk_bf16_f32 v87, v106, v107
  v_cvt_pk_bf16_f32 v91, v114, v115
  v_cvt_pk_bf16_f32 v95, v122, v123
  v_cvt_pk_bf16_f32 v99, v130, v131
  ds_write_b128 v184, v[84:87] offset:0
  ds_write_b128 v185, v[88:91] offset:0
  ds_write_b128 v184, v[92:95] offset:8192
  ds_write_b128 v185, v[96:99] offset:8192
  s_cmp_lg_u32 s13, 0
  s_cbranch_scc1 Lp1q3_13
  s_cmp_lg_u32 s12, 0
  s_cbranch_scc1 Lw_14
  s_waitcnt vmcnt(0)
Lw_14:
Lp1q3_13:
  s_waitcnt lgkmcnt(0)
  s_barrier
  s_cmp_ge_u32 s12, 2
  s_cbranch_scc1 Lp1kv_15
  v_lshrrev_b32 v13, 5, v1
  v_lshlrev_b32 v13, 3, v13
  v_bfe_u32 v15, v1, 2, 2
  v_add_u32 v13, v13, v15
  v_lshlrev_b32 v13, 6, v13
  v_and_b32 v184, 1, v1
  v_lshl_add_u32 v13, v184, 3, v13
  s_lshl_b32 s26, s12, 13
  s_add_u32 s26, s26, 131072
  v_add_u32 v13, s26, v13
  v_bfe_u32 v184, v1, 4, 1
  v_lshlrev_b32 v184, 1, v184
  v_bfe_u32 v185, v1, 1, 1
  v_or_b32 v184, v184, v185
  v_lshrrev_b32 v15, 1, v15
  v_xor_b32 v184, v184, v15
  v_xor_b32 v185, 2, v184
  v_lshl_add_u32 v185, v185, 4, v13
  v_lshl_add_u32 v13, v184, 4, v13
  ds_read_b64_tr_b16 v[148:149], v13 offset:16384
  ds_read_b64_tr_b16 v[150:151], v185 offset:16640
  ds_read_b64_tr_b16 v[152:153], v13 offset:0
  ds_read_b64_tr_b16 v[154:155], v185 offset:256
  ds_read_b64_tr_b16 v[156:157], v13 offset:17408
  ds_read_b64_tr_b16 v[158:159], v185 offset:17664
  ds_read_b64_tr_b16 v[160:161], v13 offset:1024
  ds_read_b64_tr_b16 v[162:163], v185 offset:1280
  ds_read_b64_tr_b16 v[164:165], v13 offset:18432
  ds_read_b64_tr_b16 v[166:167], v185 offset:18688
  ds_read_b64_tr_b16 v[168:169], v13 offset:2048
  ds_read_b64_tr_b16 v[170:171], v185 offset:2304
  s_waitcnt lgkmcnt(8)
  v_mfma_f32_32x32x16_bf16 v[216:231], v[148:151], v[152:155], 0
  ds_read_b64_tr_b16 v[172:173], v13 offset:19456
  ds_read_b64_tr_b16 v[174:175], v185 offset:19712
  ds_read_b64_tr_b16 v[176:177], v13 offset:3072
  ds_read_b64_tr_b16 v[178:179], v185 offset:3328
  s_waitcnt lgkmcnt(8)
  v_mfma_f32_32x32x16_bf16 v[216:231], v[156:159], v[160:163], v[216:231]
  ds_read_b64_tr_b16 v[148:149], v13 offset:20480
  ds_read_b64_tr_b16 v[150:151], v185 offset:20736
  ds_read_b64_tr_b16 v[152:153], v13 offset:4096
  ds_read_b64_tr_b16 v[154:155], v185 offset:4352
  s_cmp_eq_u32 s13, 0
  s_waitcnt lgkmcnt(8)
  v_mfma_f32_32x32x16_bf16 v[216:231], v[164:167], v[168:171], v[216:231]
  ds_read_b64_tr_b16 v[156:157], v13 offset:21504
  ds_read_b64_tr_b16 v[158:159], v185 offset:21760
  ds_read_b64_tr_b16 v[160:161], v13 offset:5120
  ds_read_b64_tr_b16 v[162:163], v185 offset:5376
  s_mov_b32 s24, 0x1500000
  s_cselect_b32 s24, 0x1300000, s24
  s_waitcnt lgkmcnt(8)
  v_mfma_f32_32x32x16_bf16 v[216:231], v[172:175], v[176:179], v[216:231]
  ds_read_b64_tr_b16 v[164:165], v13 offset:22528
  ds_read_b64_tr_b16 v[166:167], v185 offset:22784
  ds_read_b64_tr_b16 v[168:169], v13 offset:6144
  ds_read_b64_tr_b16 v[170:171], v185 offset:6400
  s_lshl_b32 s25, s15, 4
  s_waitcnt lgkmcnt(8)
  v_mfma_f32_32x32x16_bf16 v[216:231], v[148:151], v[152:155], v[216:231]
  ds_read_b64_tr_b16 v[172:173], v13 offset:23552
  ds_read_b64_tr_b16 v[174:175], v185 offset:23808
  ds_read_b64_tr_b16 v[176:177], v13 offset:7168
  ds_read_b64_tr_b16 v[178:179], v185 offset:7424
  s_add_u32 s25, s25, s14
  s_waitcnt lgkmcnt(8)
  v_mfma_f32_32x32x16_bf16 v[216:231], v[156:159], v[160:163], v[216:231]
  s_mul_i32 s25, s25, 4352
  s_add_u32 s24, s24, s25
  s_lshl_b32 s25, s12, 11
  s_add_u32 s25, s25, s24
  v_bfe_u32 v14, v1, 4, 1
  s_waitcnt lgkmcnt(4)
  v_mfma_f32_32x32x16_bf16 v[216:231], v[164:167], v[168:171], v[216:231]
  v_lshlrev_b32 v14, 10, v14
  v_lshrrev_b32 v15, 5, v1
  v_lshl_add_u32 v14, v15, 8, v14
  v_and_b32 v15, 15, v1
  v_lshl_add_u32 v14, v15, 4, v14
  s_waitcnt lgkmcnt(0)
  v_mfma_f32_32x32x16_bf16 v[216:231], v[172:175], v[176:179], v[216:231]
  v_and_b32 v15, 31, v1
  v_lshlrev_b32 v15, 2, v15
  s_lshl_b32 s27, s12, 7
  s_add_u32 s27, s27, s24
  s_add_u32 s27, s27, 4096
  s_nop 6
  buffer_store_dwordx4 v[216:219], v14, s[4:7], s25 offen sc1
  buffer_store_dwordx4 v[220:223], v14, s[4:7], s25 offen offset:512 sc1
  buffer_store_dword v224, v15, s[4:7], s27 offen sc1
  s_nop 0
  s_branch Lp1j_16
Lp1kv_15:
  s_sub_u32 s20, s12, 2
  s_lshl_b32 s20, s20, 15
  s_lshl_b32 s21, s17, 16
  s_add_u32 s21, s21, 7340032
  s_add_u32 s21, s21, s20
  s_add_u32 m0, s20, 0
  s_nop 0
  buffer_load_dwordx4 v2, s[4:7], s21 offen offset:0 sc1 lds
  buffer_load_dwordx4 v2, s[4:7], s21 offen offset:1024 sc1 lds
  buffer_load_dwordx4 v2, s[4:7], s21 offen offset:2048 sc1 lds
  buffer_load_dwordx4 v2, s[4:7], s21 offen offset:3072 sc1 lds
  s_add_u32 m0, s20, 4096
  s_add_u32 s21, s21, 4096
  buffer_load_dwordx4 v2, s[4:7], s21 offen offset:0 sc1 lds
  buffer_load_dwordx4 v2, s[4:7], s21 offen offset:1024 sc1 lds
  buffer_load_dwordx4 v2, s[4:7], s21 offen offset:2048 sc1 lds
  buffer_load_dwordx4 v2, s[4:7], s21 offen offset:3072 sc1 lds
  s_add_u32 m0, s20, 8192
  s_add_u32 s21, s21, 4096
  buffer_load_dwordx4 v2, s[4:7], s21 offen offset:0 sc1 lds
  buffer_load_dwordx4 v2, s[4:7], s21 offen offset:1024 sc1 lds
  buffer_load_dwordx4 v2, s[4:7], s21 offen offset:2048 sc1 lds
  buffer_load_dwordx4 v2, s[4:7], s21 offen offset:3072 sc1 lds
  s_add_u32 m0, s20, 12288
  s_add_u32 s21, s21, 4096
  buffer_load_dwordx4 v2, s[4:7], s21 offen offset:0 sc1 lds
  buffer_load_dwordx4 v2, s[4:7], s21 offen offset:1024 sc1 lds
  buffer_load_dwordx4 v2, s[4:7], s21 offen offset:2048 sc1 lds
  buffer_load_dwordx4 v2, s[4:7], s21 offen offset:3072 sc1 lds
  s_add_u32 m0, s20, 16384
  s_add_u32 s21, s21, 4096
  buffer_load_dwordx4 v2, s[4:7], s21 offen offset:0 sc1 lds
  buffer_load_dwordx4 v2, s[4:7], s21 offen offset:1024 sc1 lds
  buffer_load_dwordx4 v2, s[4:7], s21 offen offset:2048 sc1 lds
  buffer_load_dwordx4 v2, s[4:7], s21 offen offset:3072 sc1 lds
  s_add_u32 m0, s20, 20480
  s_add_u32 s21, s21, 4096
  buffer_load_dwordx4 v2, s[4:7], s21 offen offset:0 sc1 lds
  buffer_load_dwordx4 v2, s[4:7], s21 offen offset:1024 sc1 lds
  buffer_load_dwordx4 v2, s[4:7], s21 offen offset:2048 sc1 lds
  buffer_load_dwordx4 v2, s[4:7], s21 offen offset:3072 sc1 lds
  s_add_u32 m0, s20, 24576
  s_add_u32 s21, s21, 4096
  buffer_load_dwordx4 v2, s[4:7], s21 offen offset:0 sc1 lds
  buffer_load_dwordx4 v2, s[4:7], s21 offen offset:1024 sc1 lds
  buffer_load_dwordx4 v2, s[4:7], s21 offen offset:2048 sc1 lds
  buffer_load_dwordx4 v2, s[4:7], s21 offen offset:3072 sc1 lds
  s_add_u32 m0, s20, 28672
  s_add_u32 s21, s21, 4096
  buffer_load_dwordx4 v2, s[4:7], s21 offen offset:0 sc1 lds
  buffer_load_dwordx4 v2, s[4:7], s21 offen offset:1024 sc1 lds
  buffer_load_dwordx4 v2, s[4:7], s21 offen offset:2048 sc1 lds
  buffer_load_dwordx4 v2, s[4:7], s21 offen offset:3072 sc1 lds
Lp1j_16:
  ds_read_b128 v[148:151], v3 offset:0
  ds_read_b128 v[152:155], v3 offset:1024
  ds_read_b128 v[156:159], v3 offset:2048
  ds_read_b128 v[160:163], v3 offset:3072
  ds_read_b128 v[164:167], v3 offset:4096
  ds_read_b128 v[168:171], v3 offset:5120
  s_waitcnt lgkmcnt(4)
  v_mfma_f32_32x32x16_bf16 v[68:83], v[148:151], a[0:3], 0
  ds_read_b128 v[172:175], v3 offset:6144
  v_mfma_f32_32x32x16_bf16 v[68:83], v[152:155], a[4:7], v[68:83]
  ds_read_b128 v[176:179], v3 offset:7168
  s_waitcnt lgkmcnt(4)
  v_mfma_f32_32x32x16_bf16 v[68:83], v[156:159], a[8:11], v[68:83]
  ds_read_b128 v[148:151], v3 offset:8192
  v_mfma_f32_32x32x16_bf16 v[68:83], v[160:163], a[12:15], v[68:83]
  ds_read_b128 v[152:155], v3 offset:9216
  s_waitcnt lgkmcnt(4)
  v_mfma_f32_32x32x16_bf16 v[68:83], v[164:167], a[16:19], v[68:83]
  ds_read_b128 v[156:159], v3 offset:10240
  v_mfma_f32_32x32x16_bf16 v[68:83], v[168:171], a[20:23], v[68:83]
  ds_read_b128 v[160:163], v3 offset:11264
  s_waitcnt lgkmcnt(4)
  v_mfma_f32_32x32x16_bf16 v[68:83], v[172:175], a[24:27], v[68:83]
  ds_read_b128 v[164:167], v3 offset:12288
  v_mfma_f32_32x32x16_bf16 v[68:83], v[176:179], a[28:31], v[68:83]
  ds_read_b128 v[168:171], v3 offset:13312
  s_waitcnt lgkmcnt(4)
  v_mfma_f32_32x32x16_bf16 v[68:83], v[148:151], a[32:35], v[68:83]
  ds_read_b128 v[172:175], v3 offset:14336
  v_mfma_f32_32x32x16_bf16 v[68:83], v[152:155], a[36:39], v[68:83]
  ds_read_b128 v[176:179], v3 offset:15360
  s_waitcnt lgkmcnt(4)
  v_mfma_f32_32x32x16_bf16 v[68:83], v[156:159], a[40:43], v[68:83]
  ds_read_b128 v[148:151], v3 offset:16384
  v_mfma_f32_32x32x16_bf16 v[68:83], v[160:163], a[44:47], v[68:83]
  ds_read_b128 v[152:155], v3 offset:17408
  s_waitcnt lgkmcnt(4)
  v_mfma_f32_32x32x16_bf16 v[68:83], v[164:167], a[48:51], v[68:83]
  ds_read_b128 v[156:159], v3 offset:18432
  v_mfma_f32_32x32x16_bf16 v[68:83], v[168:171], a[52:55], v[68:83]
  ds_read_b128 v[160:163], v3 offset:19456
  s_waitcnt lgkmcnt(4)
  v_mfma_f32_32x32x16_bf16 v[68:83], v[172:175], a[56:59], v[68:83]
  ds_read_b128 v[164:167], v3 offset:20480
  v_mfma_f32_32x32x16_bf16 v[68:83], v[176:179], a[60:63], v[68:83]
  s_cmp_lg_u32 s13, 0
  s_nop 10
  s_cbranch_scc1 Lp1q0_17
  s_cmp_lt_u32 s12, 2
  s_cbranch_scc1 Lw_18
  s_waitcnt vmcnt(32)
Lw_18:
  s_cmp_ge_u32 s12, 2
  s_cbranch_scc1 Lw_19
  s_waitcnt vmcnt(0)
Lw_19:
  s_barrier
Lp1q0_17:
  s_cmp_ge_u32 s12, 2
  s_cbranch_scc1 Lp1q_20
  s_waitcnt vmcnt(0)
  s_cmp_eq_u32 s12, 0
  s_cbranch_scc1 Lkvs_21
  s_add_u32 s36, s13, 1
  s_mov_b32 s39, s36
  s_lshl_b32 s38, s2, 7
  v_mov_b32 v214, s38
  v_mov_b32 v215, s39
  s_mov_b64 exec, 1
  buffer_store_dword v215, v214, s[4:7], 0 offen offset:4 sc1
  s_mov_b64 exec, -1
  s_branch Lkvs_22
Lkvs_21:
  s_lshl_b32 s39, s13, 3
  s_add_u32 s39, s39, 2
  s_lshl_b32 s38, s2, 7
  v_mov_b32 v214, s38
  v_mov_b32 v215, s39
  s_mov_b64 exec, 1
  buffer_store_dword v215, v214, s[4:7], 0 offen offset:0 sc1
  s_mov_b64 exec, -1
Lkvs_22:
Lp1q_20:
  ds_read_b128 v[168:171], v3 offset:21504
  s_waitcnt lgkmcnt(4)
  v_mfma_f32_32x32x16_bf16 v[68:83], v[148:151], a[64:67], v[68:83]
  ds_read_b128 v[172:175], v3 offset:22528
  v_mfma_f32_32x32x16_bf16 v[68:83], v[152:155], a[68:71], v[68:83]
  ds_read_b128 v[176:179], v3 offset:23552
  s_waitcnt lgkmcnt(4)
  v_mfma_f32_32x32x16_bf16 v[68:83], v[156:159], a[72:75], v[68:83]
  ds_read_b128 v[148:151], v3 offset:24576
  v_mfma_f32_32x32x16_bf16 v[68:83], v[160:163], a[76:79], v[68:83]
  ds_read_b128 v[152:155], v3 offset:25600
  s_waitcnt lgkmcnt(4)
  v_mfma_f32_32x32x16_bf16 v[68:83], v[164:167], a[80:83], v[68:83]
  ds_read_b128 v[156:159], v3 offset:26624
  v_mfma_f32_32x32x16_bf16 v[68:83], v[168:171], a[84:87], v[68:83]
  ds_read_b128 v[160:163], v3 offset:27648
  s_waitcnt lgkmcnt(4)
  v_mfma_f32_32x32x16_bf16 v[68:83], v[172:175], a[88:91], v[68:83]
  ds_read_b128 v[164:167], v3 offset:28672
  v_mfma_f32_32x32x16_bf16 v[68:83], v[176:179], a[92:95], v[68:83]
  ds_read_b128 v[168:171], v3 offset:29696
  s_waitcnt lgkmcnt(4)
  v_mfma_f32_32x32x16_bf16 v[68:83], v[148:151], a[96:99], v[68:83]
  ds_read_b128 v[172:175], v3 offset:30720
  v_mfma_f32_32x32x16_bf16 v[68:83], v[152:155], a[100:103], v[68:83]
  ds_read_b128 v[176:179], v3 offset:31744
  s_waitcnt lgkmcnt(5)
  v_mfma_f32_32x32x16_bf16 v[68:83], v[156:159], a[104:107], v[68:83]
  s_waitcnt lgkmcnt(4)
  v_mfma_f32_32x32x16_bf16 v[68:83], v[160:163], a[108:111], v[68:83]
  s_waitcnt lgkmcnt(3)
  v_mfma_f32_32x32x16_bf16 v[68:83], v[164:167], a[112:115], v[68:83]
  s_waitcnt lgkmcnt(2)
  v_mfma_f32_32x32x16_bf16 v[68:83], v[168:171], a[116:119], v[68:83]
  s_waitcnt lgkmcnt(1)
  v_mfma_f32_32x32x16_bf16 v[68:83], v[172:175], a[120:123], v[68:83]
  s_waitcnt lgkmcnt(0)
  v_mfma_f32_32x32x16_bf16 v[68:83], v[176:179], a[124:127], v[68:83]
  v_mfma_f32_32x32x16_bf16 v[68:83], v[32:35], v[16:19], v[68:83]
  s_nop 11
  v_pk_mul_f32 v[68:69], v[68:69], v[12:13] op_sel_hi:[1,0]
  v_pk_mul_f32 v[70:71], v[70:71], v[12:13] op_sel_hi:[1,0]
  v_pk_mul_f32 v[72:73], v[72:73], v[12:13] op_sel_hi:[1,0]
  v_pk_mul_f32 v[74:75], v[74:75], v[12:13] op_sel_hi:[1,0]
  v_pk_mul_f32 v[76:77], v[76:77], v[12:13] op_sel_hi:[1,0]
  v_pk_mul_f32 v[78:79], v[78:79], v[12:13] op_sel_hi:[1,0]
  v_pk_mul_f32 v[80:81], v[80:81], v[12:13] op_sel_hi:[1,0]
  v_pk_mul_f32 v[82:83], v[82:83], v[12:13] op_sel_hi:[1,0]
  v_cvt_pk_bf16_f32 v196, v68, v69
  v_cvt_pk_bf16_f32 v197, v70, v71
  v_cvt_pk_bf16_f32 v198, v72, v73
  v_cvt_pk_bf16_f32 v199, v74, v75
  v_cvt_pk_bf16_f32 v200, v76, v77
  v_cvt_pk_bf16_f32 v201, v78, v79
  v_cvt_pk_bf16_f32 v202, v80, v81
  v_cvt_pk_bf16_f32 v203, v82, v83
  v_mfma_f32_32x32x16_bf16 v[84:99], v[4:7], v[196:199], 0
  s_nop 0
  v_mfma_f32_32x32x16_bf16 v[84:99], v[8:11], v[200:203], v[84:99]
  s_nop 11
  v_max3_f32 v132, v84, v85, v86
  v_min3_f32 v134, v84, v85, v86
  v_max3_f32 v136, v92, v93, v94
  v_min3_f32 v138, v92, v93, v94
  v_max3_f32 v132, v132, v87, v88
  v_min3_f32 v134, v134, v87, v88
  v_max3_f32 v136, v136, v95, v96
  v_min3_f32 v138, v138, v95, v96
  v_max3_f32 v132, v132, v89, v90
  v_min3_f32 v134, v134, v89, v90
  v_max3_f32 v136, v136, v97, v98
  v_min3_f32 v138, v138, v97, v98
  v_max_f32 v132, v132, v91
  v_min_f32 v134, v134, v91
  v_max_f32 v136, v136, v99
  v_min_f32 v138, v138, v99
  v_mov_b32 v140, v132
  v_mov_b32 v141, v134
  v_mov_b32 v142, v136
  v_mov_b32 v143, v138
  v_permlane32_swap_b32 v132, v140
  v_permlane32_swap_b32 v134, v141
  v_permlane32_swap_b32 v136, v142
  v_permlane32_swap_b32 v138, v143
  v_max_f32 v132, v132, v140
  v_min_f32 v134, v134, v141
  v_max_f32 v136, v136, v142
  v_min_f32 v138, v138, v143
  v_mul_f32 v132, s62, v132
  v_mul_f32 v134, s62, v134
  v_mul_f32 v136, s62, v136
  v_mul_f32 v138, s62, v138
  v_pk_fma_f32 v[100:101], v[84:85], s[62:63], v[132:133] op_sel_hi:[1,1,0] neg_lo:[0,0,1] neg_hi:[0,0,1]
  v_pk_fma_f32 v[108:109], v[84:85], s[62:63], v[134:135] op_sel_hi:[1,1,0] neg_lo:[1,0,0] neg_hi:[1,0,0]
  v_pk_fma_f32 v[116:117], v[92:93], s[62:63], v[136:137] op_sel_hi:[1,1,0] neg_lo:[0,0,1] neg_hi:[0,0,1]
  v_pk_fma_f32 v[124:125], v[92:93], s[62:63], v[138:139] op_sel_hi:[1,1,0] neg_lo:[1,0,0] neg_hi:[1,0,0]
  v_pk_fma_f32 v[102:103], v[86:87], s[62:63], v[132:133] op_sel_hi:[1,1,0] neg_lo:[0,0,1] neg_hi:[0,0,1]
  v_pk_fma_f32 v[110:111], v[86:87], s[62:63], v[134:135] op_sel_hi:[1,1,0] neg_lo:[1,0,0] neg_hi:[1,0,0]
  v_pk_fma_f32 v[118:119], v[94:95], s[62:63], v[136:137] op_sel_hi:[1,1,0] neg_lo:[0,0,1] neg_hi:[0,0,1]
  v_pk_fma_f32 v[126:127], v[94:95], s[62:63], v[138:139] op_sel_hi:[1,1,0] neg_lo:[1,0,0] neg_hi:[1,0,0]
  v_pk_fma_f32 v[104:105], v[88:89], s[62:63], v[132:133] op_sel_hi:[1,1,0] neg_lo:[0,0,1] neg_hi:[0,0,1]
  v_pk_fma_f32 v[112:113], v[88:89], s[62:63], v[134:135] op_sel_hi:[1,1,0] neg_lo:[1,0,0] neg_hi:[1,0,0]
  v_pk_fma_f32 v[120:121], v[96:97], s[62:63], v[136:137] op_sel_hi:[1,1,0] neg_lo:[0,0,1] neg_hi:[0,0,1]
  v_pk_fma_f32 v[128:129], v[96:97], s[62:63], v[138:139] op_sel_hi:[1,1,0] neg_lo:[1,0,0] neg_hi:[1,0,0]
  v_pk_fma_f32 v[106:107], v[90:91], s[62:63], v[132:133] op_sel_hi:[1,1,0] neg_lo:[0,0,1] neg_hi:[0,0,1]
  v_pk_fma_f32 v[114:115], v[90:91], s[62:63], v[134:135] op_sel_hi:[1,1,0] neg_lo:[1,0,0] neg_hi:[1,0,0]
  v_pk_fma_f32 v[122:123], v[98:99], s[62:63], v[136:137] op_sel_hi:[1,1,0] neg_lo:[0,0,1] neg_hi:[0,0,1]
  v_pk_fma_f32 v[130:131], v[98:99], s[62:63], v[138:139] op_sel_hi:[1,1,0] neg_lo:[1,0,0] neg_hi:[1,0,0]
  v_exp_f32 v100, v100
  v_exp_f32 v108, v108
  v_exp_f32 v116, v116
  v_exp_f32 v124, v124
  v_exp_f32 v101, v101
  v_exp_f32 v109, v109
  v_exp_f32 v117, v117
  v_exp_f32 v125, v125
  v_exp_f32 v102, v102
  v_exp_f32 v110, v110
  v_exp_f32 v118, v118
  v_exp_f32 v126, v126
  v_exp_f32 v103, v103
  v_exp_f32 v111, v111
  v_exp_f32 v119, v119
  v_exp_f32 v127, v127
  v_exp_f32 v104, v104
  v_exp_f32 v112, v112
  v_exp_f32 v120, v120
  v_exp_f32 v128, v128
  v_exp_f32 v105, v105
  v_exp_f32 v113, v113
  v_exp_f32 v121, v121
  v_exp_f32 v129, v129
  v_exp_f32 v106, v106
  v_exp_f32 v114, v114
  v_exp_f32 v122, v122
  v_exp_f32 v130, v130
  v_exp_f32 v107, v107
  v_exp_f32 v115, v115
  v_exp_f32 v123, v123
  v_exp_f32 v131, v131
  s_cmp_lg_u32 s12, 0
  s_nop 0
  s_cbranch_scc1 Lw_23
  v_and_b32 v215, 15, v1
  s_and_b32 s36, s15, 7
  s_lshr_b32 s37, s15, 3
  s_lshl_b32 s36, s36, 3
  s_or_b32 s36, s36, s37
  v_and_b32 v214, 3, v215
  v_lshlrev_b32 v214, 6, v214
  v_lshrrev_b32 v215, 2, v215
  v_lshl_add_u32 v214, v215, 1, v214
  v_add_u32 v214, s36, v214
  v_lshlrev_b32 v214, 7, v214
  s_lshl_b32 s39, s13, 3
  s_add_u32 s39, s39, 2
  s_add_u32 s37, s13, 1
  s_mov_b32 s38, 0
  buffer_load_dwordx2 v[210:211], v214, s[4:7], 0 offen sc1
Lw_23:
  v_pk_add_f32 v[140:141], v[100:101], v[102:103]
  v_pk_add_f32 v[142:143], v[108:109], v[110:111]
  v_pk_add_f32 v[144:145], v[116:117], v[118:119]
  v_pk_add_f32 v[146:147], v[124:125], v[126:127]
  v_pk_add_f32 v[140:141], v[140:141], v[104:105]
  v_pk_add_f32 v[142:143], v[142:143], v[112:113]
  v_pk_add_f32 v[144:145], v[144:145], v[120:121]
  v_pk_add_f32 v[146:147], v[146:147], v[128:129]
  v_pk_add_f32 v[140:141], v[140:141], v[106:107]
  v_pk_add_f32 v[142:143], v[142:143], v[114:115]
  v_pk_add_f32 v[144:145], v[144:145], v[122:123]
  v_pk_add_f32 v[146:147], v[146:147], v[130:131]
  v_add_f32 v140, v140, v141
  v_add_f32 v142, v142, v143
  v_add_f32 v144, v144, v145
  v_add_f32 v146, v146, v147
  v_mov_b32 v141, v140
  v_mov_b32 v143, v142
  v_mov_b32 v145, v144
  v_mov_b32 v147, v146
  v_permlane32_swap_b32 v140, v141
  v_permlane32_swap_b32 v142, v143
  v_permlane32_swap_b32 v144, v145
  v_permlane32_swap_b32 v146, v147
  v_add_f32 v140, v140, v141
  v_add_f32 v142, v142, v143
  v_add_f32 v144, v144, v145
  v_add_f32 v146, v146, v147
  v_rcp_f32 v140, v140
  v_rcp_f32 v142, v142
  v_rcp_f32 v144, v144
  v_rcp_f32 v146, v146
  v_pk_mul_f32 v[100:101], v[100:101], v[140:141] op_sel_hi:[1,0]
  v_pk_mul_f32 v[108:109], v[108:109], v[142:143] op_sel_hi:[1,0]
  v_pk_mul_f32 v[116:117], v[116:117], v[144:145] op_sel_hi:[1,0]
  v_pk_mul_f32 v[124:125], v[124:125], v[146:147] op_sel_hi:[1,0]
  v_pk_mul_f32 v[102:103], v[102:103], v[140:141] op_sel_hi:[1,0]
  v_pk_mul_f32 v[110:111], v[110:111], v[142:143] op_sel_hi:[1,0]
  v_pk_mul_f32 v[118:119], v[118:119], v[144:145] op_sel_hi:[1,0]
  v_pk_mul_f32 v[126:127], v[126:127], v[146:147] op_sel_hi:[1,0]
  v_pk_mul_f32 v[104:105], v[104:105], v[140:141] op_sel_hi:[1,0]
  v_pk_mul_f32 v[112:113], v[112:113], v[142:143] op_sel_hi:[1,0]
  v_pk_mul_f32 v[120:121], v[120:121], v[144:145] op_sel_hi:[1,0]
  v_pk_mul_f32 v[128:129], v[128:129], v[146:147] op_sel_hi:[1,0]
  v_pk_mul_f32 v[106:107], v[106:107], v[140:141] op_sel_hi:[1,0]
  v_pk_mul_f32 v[114:115], v[114:115], v[142:143] op_sel_hi:[1,0]
  v_pk_mul_f32 v[122:123], v[122:123], v[144:145] op_sel_hi:[1,0]
  v_pk_mul_f32 v[130:131], v[130:131], v[146:147] op_sel_hi:[1,0]
  v_cvt_pk_bf16_f32 v84, v100, v101
  v_cvt_pk_bf16_f32 v88, v108, v109
  v_cvt_pk_bf16_f32 v92, v116, v117
  v_cvt_pk_bf16_f32 v96, v124, v125
  v_cvt_pk_bf16_f32 v85, v102, v103
  v_cvt_pk_bf16_f32 v89, v110, v111
  v_cvt_pk_bf16_f32 v93, v118, v119
  v_cvt_pk_bf16_f32 v97, v126, v127
  v_cvt_pk_bf16_f32 v86, v104, v105
  v_cvt_pk_bf16_f32 v90, v112, v113
  v_cvt_pk_bf16_f32 v94, v120, v121
  v_cvt_pk_bf16_f32 v98, v128, v129
  v_cvt_pk_bf16_f32 v87, v106, v107
  v_cvt_pk_bf16_f32 v91, v114, v115
  v_cvt_pk_bf16_f32 v95, v122, v123
  v_cvt_pk_bf16_f32 v99, v130, v131
  s_cmp_lg_u32 s12, 0
  s_nop 0
  s_cbranch_scc1 Lw_26
  s_lshl_b32 s39, s13, 3
  s_add_u32 s39, s39, 2
  s_add_u32 s37, s13, 1
  s_mov_b32 s38, 0
  buffer_load_dwordx2 v[212:213], v214, s[4:7], 0 offen sc1
Lpoll_27:
  s_waitcnt vmcnt(1)
  v_cmp_gt_u32 vcc, s39, v210
  v_subrev_u32 v211, s37, v211
  v_cmp_gt_i32 s[70:71], 0, v211
  s_nop 0
  s_or_b64 vcc, vcc, s[70:71]
  s_nop 2
  s_cbranch_vccz Lpolld_28
  buffer_load_dwordx2 v[210:211], v214, s[4:7], 0 offen sc1
  s_waitcnt vmcnt(1)
  v_cmp_gt_u32 vcc, s39, v212
  v_subrev_u32 v213, s37, v213
  v_cmp_gt_i32 s[70:71], 0, v213
  s_nop 0
  s_or_b64 vcc, vcc, s[70:71]
  s_nop 2
  s_cbranch_vccz Lpolld_28
  buffer_load_dwordx2 v[212:213], v214, s[4:7], 0 offen sc1
  s_add_u32 s38, s38, 1
  s_cmp_le_u32 s38, 200000
  s_cbranch_scc1 Lpoll_27
Lpolld_28:
Lw_26:
  s_barrier
  s_cmp_eq_u32 s13, 0
  s_mov_b32 s24, 0x1500000
  s_cselect_b32 s24, 0x1300000, s24
  s_mul_i32 s25, s15, 69632
  s_add_u32 s24, s24, s25
  v_lshrrev_b32 v13, 2, v1
  s_movk_i32 s25, 4352
  v_mul_lo_u32 v13, v13, s25
  v_and_b32 v15, 3, v1
  v_lshl_add_u32 v13, v15, 4, v13
  s_lshl_b32 s25, s12, 6
  s_add_u32 s25, s25, s24
  s_add_u32 s25, s25, 4096
  buffer_load_dwordx4 v[216:219], v13, s[4:7], s25 offen sc1
  s_lshl_b32 s25, s12, 10
  s_add_u32 s24, s24, s25
  buffer_load_dwordx4 v[148:151], v2, s[4:7], s24 offen offset:0 sc1
  s_add_u32 s24, s24, 4352
  buffer_load_dwordx4 v[152:155], v2, s[4:7], s24 offen offset:0 sc1
  s_add_u32 s24, s24, 4352
  buffer_load_dwordx4 v[156:159], v2, s[4:7], s24 offen offset:0 sc1
  s_add_u32 s24, s24, 4352
  buffer_load_dwordx4 v[160:163], v2, s[4:7], s24 offen offset:0 sc1
  s_add_u32 s24, s24, 4352
  buffer_load_dwordx4 v[164:167], v2, s[4:7], s24 offen offset:0 sc1
  s_add_u32 s24, s24, 4352
  buffer_load_dwordx4 v[168:171], v2, s[4:7], s24 offen offset:0 sc1
  s_add_u32 s24, s24, 4352
  buffer_load_dwordx4 v[172:175], v2, s[4:7], s24 offen offset:0 sc1
  s_add_u32 s24, s24, 4352
  buffer_load_dwordx4 v[176:179], v2, s[4:7], s24 offen offset:0 sc1
  s_add_u32 s24, s24, 4352
  buffer_load_dwordx4 v[180:183], v2, s[4:7], s24 offen offset:0 sc1
  s_add_u32 s24, s24, 4352
  buffer_load_dwordx4 v[184:187], v2, s[4:7], s24 offen offset:0 sc1
  s_add_u32 s24, s24, 4352
  buffer_load_dwordx4 v[188:191], v2, s[4:7], s24 offen offset:0 sc1
  s_add_u32 s24, s24, 4352
  buffer_load_dwordx4 v[192:195], v2, s[4:7], s24 offen offset:0 sc1
  s_add_u32 s24, s24, 4352
  buffer_load_dwordx4 v[196:199], v2, s[4:7], s24 offen offset:0 sc1
  s_add_u32 s24, s24, 4352
  buffer_load_dwordx4 v[200:203], v2, s[4:7], s24 offen offset:0 sc1
  s_add_u32 s24, s24, 4352
  buffer_load_dwordx4 v[204:207], v2, s[4:7], s24 offen offset:0 sc1
  s_add_u32 s24, s24, 4352
  buffer_load_dwordx4 v[208:211], v2, s[4:7], s24 offen offset:0 sc1
  s_waitcnt vmcnt(16)
  v_add_f32_dpp v216, v216, v216 row_ror:4 row_mask:0xf bank_mask:0xf
  v_add_f32_dpp v217, v217, v217 row_ror:4 row_mask:0xf bank_mask:0xf
  v_add_f32_dpp v218, v218, v218 row_ror:4 row_mask:0xf bank_mask:0xf
  v_add_f32_dpp v219, v219, v219 row_ror:4 row_mask:0xf bank_mask:0xf
  v_add_f32_dpp v216, v216, v216 row_ror:8 row_mask:0xf bank_mask:0xf
  v_add_f32_dpp v217, v217, v217 row_ror:8 row_mask:0xf bank_mask:0xf
  v_add_f32_dpp v218, v218, v218 row_ror:8 row_mask:0xf bank_mask:0xf
  v_add_f32_dpp v219, v219, v219 row_ror:8 row_mask:0xf bank_mask:0xf
  v_mov_b32 v220, v216
  v_mov_b32 v221, v217
  v_mov_b32 v222, v218
  v_mov_b32 v223, v219
  v_permlane16_swap_b32 v216, v220
  v_permlane16_swap_b32 v217, v221
  v_permlane16_swap_b32 v218, v222
  v_permlane16_swap_b32 v219, v223
  v_add_f32 v216, v216, v220
  v_add_f32 v217, v217, v221
  v_add_f32 v218, v218, v222
  v_add_f32 v219, v219, v223
  v_mov_b32 v220, v216
  v_mov_b32 v221, v217
  v_mov_b32 v222, v218
  v_mov_b32 v223, v219
  v_permlane32_swap_b32 v216, v220
  v_permlane32_swap_b32 v217, v221
  v_permlane32_swap_b32 v218, v222
  v_permlane32_swap_b32 v219, v223
  v_add_f32 v216, v216, v220
  v_add_f32 v217, v217, v221
  v_add_f32 v218, v218, v222
  v_add_f32 v219, v219, v223
  v_cvt_pk_bf16_f32 v216, v216, v217
  v_cvt_pk_bf16_f32 v217, v218, v219
  s_lshl_b32 s25, s12, 10
  s_add_u32 s25, s25, 131072
  v_and_b32 v15, 3, v1
  v_lshlrev_b32 v15, 3, v15
  v_add_u32 v15, s25, v15
  ds_write_b64 v15, v[216:217] offset:512
  s_waitcnt vmcnt(14)
  v_pk_add_f32 v[100:101], v[148:149], v[152:153]
  v_pk_add_f32 v[102:103], v[150:151], v[154:155]
  s_waitcnt vmcnt(13)
  v_pk_add_f32 v[100:101], v[100:101], v[156:157]
  v_pk_add_f32 v[102:103], v[102:103], v[158:159]
  s_waitcnt vmcnt(12)
  v_pk_add_f32 v[100:101], v[100:101], v[160:161]
  v_pk_add_f32 v[102:103], v[102:103], v[162:163]
  s_waitcnt vmcnt(11)
  v_pk_add_f32 v[100:101], v[100:101], v[164:165]
  v_pk_add_f32 v[102:103], v[102:103], v[166:167]
  s_waitcnt vmcnt(10)
  v_pk_add_f32 v[100:101], v[100:101], v[168:169]
  v_pk_add_f32 v[102:103], v[102:103], v[170:171]
  s_waitcnt vmcnt(9)
  v_pk_add_f32 v[100:101], v[100:101], v[172:173]
  v_pk_add_f32 v[102:103], v[102:103], v[174:175]
  s_waitcnt vmcnt(8)
  v_pk_add_f32 v[100:101], v[100:101], v[176:177]
  v_pk_add_f32 v[102:103], v[102:103], v[178:179]
  s_waitcnt vmcnt(7)
  v_pk_add_f32 v[100:101], v[100:101], v[180:181]
  v_pk_add_f32 v[102:103], v[102:103], v[182:183]
  s_waitcnt vmcnt(6)
  v_pk_add_f32 v[100:101], v[100:101], v[184:185]
  v_pk_add_f32 v[102:103], v[102:103], v[186:187]
  s_waitcnt vmcnt(5)
  v_pk_add_f32 v[100:101], v[100:101], v[188:189]
  v_pk_add_f32 v[102:103], v[102:103], v[190:191]
  s_waitcnt vmcnt(4)
  v_pk_add_f32 v[100:101], v[100:101], v[192:193]
  v_pk_add_f32 v[102:103], v[102:103], v[194:195]
  s_waitcnt vmcnt(3)
  v_pk_add_f32 v[100:101], v[100:101], v[196:197]
  v_pk_add_f32 v[102:103], v[102:103], v[198:199]
  s_waitcnt vmcnt(2)
  v_pk_add_f32 v[100:101], v[100:101], v[200:201]
  v_pk_add_f32 v[102:103], v[102:103], v[202:203]
  s_waitcnt vmcnt(1)
  v_pk_add_f32 v[100:101], v[100:101], v[204:205]
  v_pk_add_f32 v[102:103], v[102:103], v[206:207]
  s_waitcnt vmcnt(0)
  v_pk_add_f32 v[100:101], v[100:101], v[208:209]
  v_pk_add_f32 v[102:103], v[102:103], v[210:211]
  v_cvt_pk_bf16_f32 v104, v100, v101
  v_cvt_pk_bf16_f32 v105, v102, v103
  v_lshrrev_b32 v13, 4, v1
  v_lshlrev_b32 v13, 7, v13
  v_and_b32 v15, 15, v1
  v_lshl_add_u32 v13, v15, 1, v13
  v_add_u32 v13, s25, v13
  ds_write_b16 v13, v104
  ds_write_b16_d16_hi v13, v104 offset:32
  ds_write_b16 v13, v105 offset:64
  ds_write_b16_d16_hi v13, v105 offset:96
  s_waitcnt lgkmcnt(0)
  s_barrier
  v_and_b32 v13, 31, v1
  v_min_u32 v13, 16, v13
  v_lshlrev_b32 v13, 5, v13
  v_lshrrev_b32 v15, 5, v1
  v_lshl_add_u32 v13, v15, 4, v13
  v_add_u32 v13, 131072, v13
  ds_read_b128 v[108:111], v13 offset:0
  ds_read_b128 v[112:115], v13 offset:1024
  ds_read_b128 v[116:119], v13 offset:2048
  ds_read_b128 v[120:123], v13 offset:3072
  s_waitcnt lgkmcnt(3)
  v_mfma_f32_32x32x16_bf16 v[36:51], v[108:111], v[84:87], 0
  s_waitcnt lgkmcnt(1)
  v_mfma_f32_32x32x16_bf16 v[52:67], v[116:119], v[92:95], 0
  v_mfma_f32_32x32x16_bf16 v[36:51], v[112:115], v[88:91], v[36:51]
  s_waitcnt lgkmcnt(0)
  v_mfma_f32_32x32x16_bf16 v[52:67], v[120:123], v[96:99], v[52:67]
  s_cmp_eq_u32 s13, 0
  s_mov_b32 s24, 0x1900000
  s_cselect_b32 s24, 0x1700000, s24
  s_lshl_b32 s23, s14, 2
  s_add_u32 s23, s23, s12
  s_lshl_b32 s23, s23, 15
  s_add_u32 s24, s24, s23
  s_lshl_b32 s23, s15, 11
  s_add_u32 s24, s24, s23
  s_nop 0
  v_add_f32 v44, 0x358637bd, v44
  s_nop 0
  v_add_f32 v60, 0x358637bd, v60
  v_rcp_f32 v44, v44
  v_rcp_f32 v60, v60
  v_pk_mul_f32 v[36:37], v[36:37], v[44:45] op_sel_hi:[1,0]
  v_pk_mul_f32 v[38:39], v[38:39], v[44:45] op_sel_hi:[1,0]
  v_pk_mul_f32 v[40:41], v[40:41], v[44:45] op_sel_hi:[1,0]
  v_pk_mul_f32 v[42:43], v[42:43], v[44:45] op_sel_hi:[1,0]
  v_cvt_pk_bf16_f32 v68, v36, v37
  v_cvt_pk_bf16_f32 v69, v38, v39
  v_cvt_pk_bf16_f32 v70, v40, v41
  v_cvt_pk_bf16_f32 v71, v42, v43
  buffer_store_dwordx4 v[68:71], v2, s[4:7], s24 offen offset:0 sc1
  v_pk_mul_f32 v[52:53], v[52:53], v[60:61] op_sel_hi:[1,0]
  v_pk_mul_f32 v[54:55], v[54:55], v[60:61] op_sel_hi:[1,0]
  v_pk_mul_f32 v[56:57], v[56:57], v[60:61] op_sel_hi:[1,0]
  v_pk_mul_f32 v[58:59], v[58:59], v[60:61] op_sel_hi:[1,0]
  v_cvt_pk_bf16_f32 v72, v52, v53
  v_cvt_pk_bf16_f32 v73, v54, v55
  v_cvt_pk_bf16_f32 v74, v56, v57
  v_cvt_pk_bf16_f32 v75, v58, v59
  buffer_store_dwordx4 v[72:75], v2, s[4:7], s24 offen offset:1024 sc1
  s_cmp_eq_u32 s12, 0
  s_nop 0
  s_cbranch_scc1 Lw_29
  s_cmp_eq_u32 s13, 0
  s_cbranch_scc1 Lcd_30
  s_mul_i32 s20, s19, 236544
  s_add_u32 s20, s20, 3145728
  s_sub_u32 s21, s12, 1
  s_mul_i32 s21, s21, 2
  s_add_u32 s21, s21, 0
  s_min_u32 s21, s21, 4
  s_add_u32 s22, s21, 0
  s_lshr_b32 s23, s22, 3
  s_mul_i32 s23, s23, 33792
  s_and_b32 s24, s22, 7
  s_lshl_b32 s24, s24, 12
  s_add_u32 s23, s23, s24
  s_add_u32 s23, s23, s20
  s_lshl_b32 s24, s22, 12
  s_add_u32 m0, s24, 65536
  s_nop 0
  buffer_load_dwordx4 v2, s[4:7], s23 offen offset:0 sc1 lds
  buffer_load_dwordx4 v2, s[4:7], s23 offen offset:1024 sc1 lds
  buffer_load_dwordx4 v2, s[4:7], s23 offen offset:2048 sc1 lds
  buffer_load_dwordx4 v2, s[4:7], s23 offen offset:3072 sc1 lds
  s_add_u32 s22, s21, 1
  s_lshr_b32 s23, s22, 3
  s_mul_i32 s23, s23, 33792
  s_and_b32 s24, s22, 7
  s_lshl_b32 s24, s24, 12
  s_add_u32 s23, s23, s24
  s_add_u32 s23, s23, s20
  s_lshl_b32 s24, s22, 12
  s_add_u32 m0, s24, 65536
  s_nop 0
  buffer_load_dwordx4 v2, s[4:7], s23 offen offset:0 sc1 lds
  buffer_load_dwordx4 v2, s[4:7], s23 offen offset:1024 sc1 lds
  buffer_load_dwordx4 v2, s[4:7], s23 offen offset:2048 sc1 lds
  buffer_load_dwordx4 v2, s[4:7], s23 offen offset:3072 sc1 lds
  s_waitcnt vmcnt(8)
  s_branch Lcde_31
Lcd_30:
  s_waitcnt vmcnt(0)
Lcde_31:
Lw_29:
  s_cmp_lg_u32 s12, 0
  s_cbranch_scc1 Lw_32
  s_waitcnt vmcnt(0)
Lw_32:
  s_barrier
  s_cmp_lg_u32 s12, 0
  s_cbranch_scc1 Lw_33
  s_lshl_b32 s39, s13, 3
  s_add_u32 s39, s39, 4
  s_lshl_b32 s38, s2, 7
  v_mov_b32 v214, s38
  v_mov_b32 v215, s39
  s_mov_b64 exec, 1
  buffer_store_dword v215, v214, s[4:7], 0 offen offset:0 sc1
  s_mov_b64 exec, -1
Lw_33:
  s_cmp_eq_u32 s12, 0
  s_cbranch_scc1 Lw_34
  s_cmp_eq_u32 s13, 0
  s_cbranch_scc1 Lop_35
  s_mul_i32 s20, s19, 236544
  s_add_u32 s20, s20, 3145728
  s_sub_u32 s21, s12, 1
  s_mul_i32 s21, s21, 6
  s_add_u32 s21, s21, 6
  s_min_u32 s21, s21, 18
  s_add_u32 s22, s21, 0
  s_lshr_b32 s23, s22, 3
  s_mul_i32 s23, s23, 33792
  s_and_b32 s24, s22, 7
  s_lshl_b32 s24, s24, 12
  s_add_u32 s23, s23, s24
  s_add_u32 s23, s23, s20
  s_lshl_b32 s24, s22, 12
  s_add_u32 m0, s24, 65536
  s_nop 0
  buffer_load_dwordx4 v2, s[4:7], s23 offen offset:0 sc1 lds
  buffer_load_dwordx4 v2, s[4:7], s23 offen offset:1024 sc1 lds
  buffer_load_dwordx4 v2, s[4:7], s23 offen offset:2048 sc1 lds
  buffer_load_dwordx4 v2, s[4:7], s23 offen offset:3072 sc1 lds
  s_add_u32 s22, s21, 1
  s_lshr_b32 s23, s22, 3
  s_mul_i32 s23, s23, 33792
  s_and_b32 s24, s22, 7
  s_lshl_b32 s24, s24, 12
  s_add_u32 s23, s23, s24
  s_add_u32 s23, s23, s20
  s_lshl_b32 s24, s22, 12
  s_add_u32 m0, s24, 65536
  s_nop 0
  buffer_load_dwordx4 v2, s[4:7], s23 offen offset:0 sc1 lds
  buffer_load_dwordx4 v2, s[4:7], s23 offen offset:1024 sc1 lds
  buffer_load_dwordx4 v2, s[4:7], s23 offen offset:2048 sc1 lds
  buffer_load_dwordx4 v2, s[4:7], s23 offen offset:3072 sc1 lds
  s_add_u32 s22, s21, 2
  s_lshr_b32 s23, s22, 3
  s_mul_i32 s23, s23, 33792
  s_and_b32 s24, s22, 7
  s_lshl_b32 s24, s24, 12
  s_add_u32 s23, s23, s24
  s_add_u32 s23, s23, s20
  s_lshl_b32 s24, s22, 12
  s_add_u32 m0, s24, 65536
  s_nop 0
  buffer_load_dwordx4 v2, s[4:7], s23 offen offset:0 sc1 lds
  buffer_load_dwordx4 v2, s[4:7], s23 offen offset:1024 sc1 lds
  buffer_load_dwordx4 v2, s[4:7], s23 offen offset:2048 sc1 lds
  buffer_load_dwordx4 v2, s[4:7], s23 offen offset:3072 sc1 lds
  s_add_u32 s22, s21, 3
  s_lshr_b32 s23, s22, 3
  s_mul_i32 s23, s23, 33792
  s_and_b32 s24, s22, 7
  s_lshl_b32 s24, s24, 12
  s_add_u32 s23, s23, s24
  s_add_u32 s23, s23, s20
  s_lshl_b32 s24, s22, 12
  s_add_u32 m0, s24, 65536
  s_nop 0
  buffer_load_dwordx4 v2, s[4:7], s23 offen offset:0 sc1 lds
  buffer_load_dwordx4 v2, s[4:7], s23 offen offset:1024 sc1 lds
  buffer_load_dwordx4 v2, s[4:7], s23 offen offset:2048 sc1 lds
  buffer_load_dwordx4 v2, s[4:7], s23 offen offset:3072 sc1 lds
  s_add_u32 s22, s21, 4
  s_lshr_b32 s23, s22, 3
  s_mul_i32 s23, s23, 33792
  s_and_b32 s24, s22, 7
  s_lshl_b32 s24, s24, 12
  s_add_u32 s23, s23, s24
  s_add_u32 s23, s23, s20
  s_lshl_b32 s24, s22, 12
  s_add_u32 m0, s24, 65536
  s_nop 0
  buffer_load_dwordx4 v2, s[4:7], s23 offen offset:0 sc1 lds
  buffer_load_dwordx4 v2, s[4:7], s23 offen offset:1024 sc1 lds
  buffer_load_dwordx4 v2, s[4:7], s23 offen offset:2048 sc1 lds
  buffer_load_dwordx4 v2, s[4:7], s23 offen offset:3072 sc1 lds
  s_add_u32 s22, s21, 5
  s_lshr_b32 s23, s22, 3
  s_mul_i32 s23, s23, 33792
  s_and_b32 s24, s22, 7
  s_lshl_b32 s24, s24, 12
  s_add_u32 s23, s23, s24
  s_add_u32 s23, s23, s20
  s_lshl_b32 s24, s22, 12
  s_add_u32 m0, s24, 65536
  s_nop 0
  buffer_load_dwordx4 v2, s[4:7], s23 offen offset:0 sc1 lds
  buffer_load_dwordx4 v2, s[4:7], s23 offen offset:1024 sc1 lds
  buffer_load_dwordx4 v2, s[4:7], s23 offen offset:2048 sc1 lds
  buffer_load_dwordx4 v2, s[4:7], s23 offen offset:3072 sc1 lds
Lop_35:
Lw_34:
  s_cmp_lg_u32 s12, 0
  s_cbranch_scc1 Lw_36
  v_and_b32 v215, 15, v1
  s_lshr_b32 s36, s16, 1
  s_and_b32 s37, s36, 3
  s_lshl_b32 s37, s37, 6
  s_lshr_b32 s36, s36, 2
  s_lshl_b32 s36, s36, 1
  s_or_b32 s36, s36, s37
  v_and_b32 v214, 7, v215
  v_lshlrev_b32 v214, 3, v214
  v_lshrrev_b32 v215, 3, v215
  v_add_u32 v214, v214, v215
  v_add_u32 v214, s36, v214
  v_lshlrev_b32 v214, 7, v214
  s_lshl_b32 s39, s13, 3
  s_add_u32 s39, s39, 4
  s_mov_b32 s38, 0
  buffer_load_dword v210, v214, s[4:7], 0 offen sc1
  buffer_load_dword v212, v214, s[4:7], 0 offen sc1
Lpoll_37:
  s_waitcnt vmcnt(1)
  v_cmp_gt_u32 vcc, s39, v210
  s_nop 4
  s_cbranch_vccz Lpolld_38
  buffer_load_dword v210, v214, s[4:7], 0 offen sc1
  s_waitcnt vmcnt(1)
  v_cmp_gt_u32 vcc, s39, v212
  s_nop 4
  s_cbranch_vccz Lpolld_38
  buffer_load_dword v212, v214, s[4:7], 0 offen sc1
  s_add_u32 s38, s38, 1
  s_cmp_le_u32 s38, 200000
  s_cbranch_scc1 Lpoll_37
Lpolld_38:
Lw_36:
  s_barrier
  s_cmp_eq_u32 s13, 0
  s_mov_b32 s20, 0x1900000
  s_cselect_b32 s20, 0x1700000, s20
  s_lshl_b32 s21, s12, 13
  s_add_u32 s20, s20, s21
  s_lshr_b32 s21, s12, 1
  s_xor_b32 s22, s21, 0
  s_lshl_b32 s23, s16, 1
  s_add_u32 s22, s22, s23
  s_lshl_b32 s22, s22, 15
  s_add_u32 s30, s20, s22
  s_xor_b32 s22, s21, 1
  s_lshl_b32 s23, s16, 1
  s_add_u32 s22, s22, s23
  s_lshl_b32 s22, s22, 15
  s_add_u32 s31, s20, s22
  buffer_load_dwordx4 a[0:3], v2, s[4:7], s30 offen offset:0 sc1
  buffer_load_dwordx4 a[4:7], v2, s[4:7], s31 offen offset:0 sc1
  buffer_load_dwordx4 a[8:11], v2, s[4:7], s30 offen offset:1024 sc1
  buffer_load_dwordx4 a[12:15], v2, s[4:7], s31 offen offset:1024 sc1
  buffer_load_dwordx4 a[16:19], v2, s[4:7], s30 offen offset:2048 sc1
  buffer_load_dwordx4 a[20:23], v2, s[4:7], s31 offen offset:2048 sc1
  buffer_load_dwordx4 a[24:27], v2, s[4:7], s30 offen offset:3072 sc1
  buffer_load_dwordx4 a[28:31], v2, s[4:7], s31 offen offset:3072 sc1
  s_add_u32 s30, s30, 4096
  buffer_load_dwordx4 a[32:35], v2, s[4:7], s30 offen offset:0 sc1
  s_add_u32 s31, s31, 4096
  buffer_load_dwordx4 a[36:39], v2, s[4:7], s31 offen offset:0 sc1
  s_lshl_b32 s20, s12, 14
  s_and_b32 s21, s12, 1
  s_xor_b32 s22, s21, 0
  s_lshl_b32 s22, s22, 10
  s_add_u32 s22, s22, s20
  v_add_u32 v14, s22, v2
  s_xor_b32 s22, s21, 1
  s_lshl_b32 s22, s22, 10
  s_add_u32 s22, s22, s20
  v_add_u32 v15, s22, v2
  ds_read_b128 v[96:99], v14 offset:0
  ds_read_b128 v[100:103], v15 offset:0
  ds_read_b128 v[104:107], v14 offset:2048
  ds_read_b128 v[108:111], v15 offset:2048
  ds_read_b128 v[112:115], v14 offset:4096
  ds_read_b128 v[116:119], v15 offset:4096
  s_waitcnt vmcnt(9) lgkmcnt(5)
  v_mfma_f32_32x32x16_bf16 v[32:47], v[96:99], a[0:3], 0
  s_waitcnt vmcnt(8)
  v_mfma_f32_32x32x16_bf16 v[64:79], v[96:99], a[4:7], 0
  ds_read_b128 v[120:123], v14 offset:6144
  s_waitcnt lgkmcnt(5)
  v_mfma_f32_32x32x16_bf16 v[48:63], v[100:103], a[0:3], 0
  v_mfma_f32_32x32x16_bf16 v[80:95], v[100:103], a[4:7], 0
  ds_read_b128 v[124:127], v15 offset:6144
  buffer_load_dwordx4 a[40:43], v2, s[4:7], s30 offen offset:1024 sc1
  buffer_load_dwordx4 a[44:47], v2, s[4:7], s31 offen offset:1024 sc1
  s_waitcnt vmcnt(9) lgkmcnt(5)
  v_mfma_f32_32x32x16_bf16 v[32:47], v[104:107], a[8:11], v[32:47]
  s_waitcnt vmcnt(8)
  v_mfma_f32_32x32x16_bf16 v[64:79], v[104:107], a[12:15], v[64:79]
  ds_read_b128 v[96:99], v14 offset:8192
  s_waitcnt lgkmcnt(5)
  v_mfma_f32_32x32x16_bf16 v[48:63], v[108:111], a[8:11], v[48:63]
  v_mfma_f32_32x32x16_bf16 v[80:95], v[108:111], a[12:15], v[80:95]
  ds_read_b128 v[100:103], v15 offset:8192
  buffer_load_dwordx4 a[48:51], v2, s[4:7], s30 offen offset:2048 sc1
  buffer_load_dwordx4 a[52:55], v2, s[4:7], s31 offen offset:2048 sc1
  s_waitcnt vmcnt(9) lgkmcnt(5)
  v_mfma_f32_32x32x16_bf16 v[32:47], v[112:115], a[16:19], v[32:47]
  s_waitcnt vmcnt(8)
  v_mfma_f32_32x32x16_bf16 v[64:79], v[112:115], a[20:23], v[64:79]
  ds_read_b128 v[104:107], v14 offset:10240
  s_waitcnt lgkmcnt(5)
  v_mfma_f32_32x32x16_bf16 v[48:63], v[116:119], a[16:19], v[48:63]
  v_mfma_f32_32x32x16_bf16 v[80:95], v[116:119], a[20:23], v[80:95]
  ds_read_b128 v[108:111], v15 offset:10240
  buffer_load_dwordx4 a[56:59], v2, s[4:7], s30 offen offset:3072 sc1
  buffer_load_dwordx4 a[60:63], v2, s[4:7], s31 offen offset:3072 sc1
  s_waitcnt vmcnt(9) lgkmcnt(5)
  v_mfma_f32_32x32x16_bf16 v[32:47], v[120:123], a[24:27], v[32:47]
  s_waitcnt vmcnt(8)
  v_mfma_f32_32x32x16_bf16 v[64:79], v[120:123], a[28:31], v[64:79]
  ds_read_b128 v[112:115], v14 offset:12288
  s_waitcnt lgkmcnt(5)
  v_mfma_f32_32x32x16_bf16 v[48:63], v[124:127], a[24:27], v[48:63]
  v_mfma_f32_32x32x16_bf16 v[80:95], v[124:127], a[28:31], v[80:95]
  ds_read_b128 v[116:119], v15 offset:12288
  s_lshl_b32 s23, s16, 1
  s_lshr_b32 s24, s12, 1
  s_add_u32 s23, s23, s24
  s_lshl_b32 s24, s17, 1
  s_and_b32 s25, s12, 1
  s_add_u32 s24, s24, s25
  s_cmp_eq_u32 s13, 0
  s_mov_b32 s25, 0xe00000
  s_cselect_b32 s25, 0xa00000, s25
  s_lshl_b32 s26, s23, 15
  s_add_u32 s25, s25, s26
  s_lshl_b32 s26, s24, 11
  s_add_u32 s25, s25, s26
  buffer_load_dwordx4 v[224:227], v2, s[4:7], s25 offen sc1
  buffer_load_dwordx4 v[228:231], v2, s[4:7], s25 offen offset:1024 sc1
  s_waitcnt vmcnt(9) lgkmcnt(5)
  v_mfma_f32_32x32x16_bf16 v[32:47], v[96:99], a[32:35], v[32:47]
  s_waitcnt vmcnt(8)
  v_mfma_f32_32x32x16_bf16 v[64:79], v[96:99], a[36:39], v[64:79]
  ds_read_b128 v[120:123], v14 offset:14336
  s_waitcnt lgkmcnt(5)
  v_mfma_f32_32x32x16_bf16 v[48:63], v[100:103], a[32:35], v[48:63]
  v_mfma_f32_32x32x16_bf16 v[80:95], v[100:103], a[36:39], v[80:95]
  ds_read_b128 v[124:127], v15 offset:14336
  s_waitcnt vmcnt(7) lgkmcnt(5)
  v_mfma_f32_32x32x16_bf16 v[32:47], v[104:107], a[40:43], v[32:47]
  s_waitcnt vmcnt(6)
  v_mfma_f32_32x32x16_bf16 v[64:79], v[104:107], a[44:47], v[64:79]
  s_waitcnt lgkmcnt(4)
  v_mfma_f32_32x32x16_bf16 v[48:63], v[108:111], a[40:43], v[48:63]
  v_mfma_f32_32x32x16_bf16 v[80:95], v[108:111], a[44:47], v[80:95]
  s_waitcnt vmcnt(5) lgkmcnt(3)
  v_mfma_f32_32x32x16_bf16 v[32:47], v[112:115], a[48:51], v[32:47]
  s_waitcnt vmcnt(4)
  v_mfma_f32_32x32x16_bf16 v[64:79], v[112:115], a[52:55], v[64:79]
  s_waitcnt lgkmcnt(2)
  v_mfma_f32_32x32x16_bf16 v[48:63], v[116:119], a[48:51], v[48:63]
  v_mfma_f32_32x32x16_bf16 v[80:95], v[116:119], a[52:55], v[80:95]
  s_waitcnt vmcnt(3) lgkmcnt(1)
  v_mfma_f32_32x32x16_bf16 v[32:47], v[120:123], a[56:59], v[32:47]
  s_waitcnt vmcnt(2)
  v_mfma_f32_32x32x16_bf16 v[64:79], v[120:123], a[60:63], v[64:79]
  s_waitcnt lgkmcnt(0)
  v_mfma_f32_32x32x16_bf16 v[48:63], v[124:127], a[56:59], v[48:63]
  v_mfma_f32_32x32x16_bf16 v[80:95], v[124:127], a[60:63], v[80:95]
  s_mul_i32 s26, s12, 16384
  s_add_u32 s26, s26, 0
  v_add_u32 v13, s26, v2
  s_nop 7
  ds_write_b128 v13, v[48:51] offset:4096
  ds_write_b128 v13, v[52:55] offset:5120
  ds_write_b128 v13, v[56:59] offset:6144
  ds_write_b128 v13, v[60:63] offset:7168
  ds_write_b128 v13, v[64:67] offset:8192
  ds_write_b128 v13, v[68:71] offset:9216
  ds_write_b128 v13, v[72:75] offset:10240
  ds_write_b128 v13, v[76:79] offset:11264
  ds_write_b128 v13, v[80:83] offset:12288
  ds_write_b128 v13, v[84:87] offset:13312
  ds_write_b128 v13, v[88:91] offset:14336
  ds_write_b128 v13, v[92:95] offset:15360
  s_xor_b32 s27, s12, 1
  s_mul_i32 s27, s27, 16384
  s_add_u32 s27, s27, 4096
  v_add_u32 v25, s27, v2
  s_xor_b32 s27, s12, 2
  s_mul_i32 s27, s27, 16384
  s_add_u32 s27, s27, 8192
  v_add_u32 v26, s27, v2
  s_xor_b32 s27, s12, 3
  s_mul_i32 s27, s27, 16384
  s_add_u32 s27, s27, 12288
  v_add_u32 v27, s27, v2
  s_waitcnt lgkmcnt(0)
  s_barrier
  ds_read_b128 v[232:235], v25 offset:0
  ds_read_b128 v[236:239], v25 offset:1024
  ds_read_b128 v[240:243], v25 offset:2048
  ds_read_b128 v[244:247], v25 offset:3072
  ds_read_b128 v[248:251], v26 offset:0
  ds_read_b128 v[252:255], v26 offset:1024
  s_waitcnt vmcnt(1)
  v_lshlrev_b32 v48, 16, v224
  v_and_b32 v49, 0xffff0000, v224
  v_lshlrev_b32 v50, 16, v225
  v_and_b32 v51, 0xffff0000, v225
  v_lshlrev_b32 v52, 16, v226
  v_and_b32 v53, 0xffff0000, v226
  v_lshlrev_b32 v54, 16, v227
  v_and_b32 v55, 0xffff0000, v227
  s_waitcnt vmcnt(0)
  v_lshlrev_b32 v56, 16, v228
  v_and_b32 v57, 0xffff0000, v228
  v_lshlrev_b32 v58, 16, v229
  v_and_b32 v59, 0xffff0000, v229
  v_lshlrev_b32 v60, 16, v230
  v_and_b32 v61, 0xffff0000, v230
  v_lshlrev_b32 v62, 16, v231
  v_and_b32 v63, 0xffff0000, v231
  v_pk_add_f32 v[32:33], v[32:33], v[48:49]
  v_pk_add_f32 v[34:35], v[34:35], v[50:51]
  v_pk_add_f32 v[36:37], v[36:37], v[52:53]
  v_pk_add_f32 v[38:39], v[38:39], v[54:55]
  v_pk_add_f32 v[40:41], v[40:41], v[56:57]
  v_pk_add_f32 v[42:43], v[42:43], v[58:59]
  v_pk_add_f32 v[44:45], v[44:45], v[60:61]
  v_pk_add_f32 v[46:47], v[46:47], v[62:63]
  s_waitcnt lgkmcnt(5)
  v_pk_add_f32 v[32:33], v[32:33], v[232:233]
  v_pk_add_f32 v[34:35], v[34:35], v[234:235]
  ds_read_b128 v[232:235], v26 offset:2048
  s_waitcnt lgkmcnt(5)
  v_pk_add_f32 v[36:37], v[36:37], v[236:237]
  v_pk_add_f32 v[38:39], v[38:39], v[238:239]
  ds_read_b128 v[236:239], v26 offset:3072
  s_waitcnt lgkmcnt(5)
  v_pk_add_f32 v[40:41], v[40:41], v[240:241]
  v_pk_add_f32 v[42:43], v[42:43], v[242:243]
  ds_read_b128 v[240:243], v27 offset:0
  s_waitcnt lgkmcnt(5)
  v_pk_add_f32 v[44:45], v[44:45], v[244:245]
  v_pk_add_f32 v[46:47], v[46:47], v[246:247]
  ds_read_b128 v[244:247], v27 offset:1024
  s_waitcnt lgkmcnt(5)
  v_pk_add_f32 v[32:33], v[32:33], v[248:249]
  v_pk_add_f32 v[34:35], v[34:35], v[250:251]
  ds_read_b128 v[248:251], v27 offset:2048
  s_waitcnt lgkmcnt(5)
  v_pk_add_f32 v[36:37], v[36:37], v[252:253]
  v_pk_add_f32 v[38:39], v[38:39], v[254:255]
  ds_read_b128 v[252:255], v27 offset:3072
  s_waitcnt lgkmcnt(5)
  v_pk_add_f32 v[40:41], v[40:41], v[232:233]
  v_pk_add_f32 v[42:43], v[42:43], v[234:235]
  s_waitcnt lgkmcnt(4)
  v_pk_add_f32 v[44:45], v[44:45], v[236:237]
  v_pk_add_f32 v[46:47], v[46:47], v[238:239]
  s_waitcnt lgkmcnt(3)
  v_pk_add_f32 v[32:33], v[32:33], v[240:241]
  v_pk_add_f32 v[34:35], v[34:35], v[242:243]
  s_waitcnt lgkmcnt(2)
  v_pk_add_f32 v[36:37], v[36:37], v[244:245]
  v_pk_add_f32 v[38:39], v[38:39], v[246:247]
  s_waitcnt lgkmcnt(1)
  v_pk_add_f32 v[40:41], v[40:41], v[248:249]
  v_pk_add_f32 v[42:43], v[42:43], v[250:251]
  s_waitcnt lgkmcnt(0)
  v_pk_add_f32 v[44:45], v[44:45], v[252:253]
  v_pk_add_f32 v[46:47], v[46:47], v[254:255]
  v_cvt_pk_bf16_f32 v224, v32, v33
  v_cvt_pk_bf16_f32 v225, v34, v35
  v_cvt_pk_bf16_f32 v226, v36, v37
  v_cvt_pk_bf16_f32 v227, v38, v39
  v_cvt_pk_bf16_f32 v228, v40, v41
  v_cvt_pk_bf16_f32 v229, v42, v43
  v_cvt_pk_bf16_f32 v230, v44, v45
  v_cvt_pk_bf16_f32 v231, v46, v47
  s_cmp_eq_u32 s13, 0
  s_mov_b32 s28, 0x1000000
  s_cselect_b32 s28, 0xc00000, s28
  s_cmp_eq_u32 s13, 0
  s_mov_b32 s29, 0x12c0000
  s_cselect_b32 s29, 0x1240000, s29
  s_lshl_b32 s23, s16, 1
  s_lshr_b32 s24, s12, 1
  s_add_u32 s23, s23, s24
  s_lshl_b32 s24, s17, 1
  s_and_b32 s25, s12, 1
  s_add_u32 s24, s24, s25
  s_lshl_b32 s25, s23, 15
  s_add_u32 s25, s25, s28
  s_lshl_b32 s26, s24, 11
  s_add_u32 s25, s25, s26
  buffer_store_dwordx4 v[224:227], v2, s[4:7], s25 offen sc1
  buffer_store_dwordx4 v[228:231], v2, s[4:7], s25 offen offset:1024 sc1
  v_pk_mul_f32 v[234:235], v[32:33], v[32:33]
  v_pk_add_f32 v[232:233], v[32:33], v[34:35]
  v_pk_fma_f32 v[234:235], v[34:35], v[34:35], v[234:235]
  v_pk_add_f32 v[232:233], v[232:233], v[36:37]
  v_pk_fma_f32 v[234:235], v[36:37], v[36:37], v[234:235]
  v_pk_add_f32 v[232:233], v[232:233], v[38:39]
  v_pk_fma_f32 v[234:235], v[38:39], v[38:39], v[234:235]
  v_pk_add_f32 v[232:233], v[232:233], v[40:41]
  v_pk_fma_f32 v[234:235], v[40:41], v[40:41], v[234:235]
  v_pk_add_f32 v[232:233], v[232:233], v[42:43]
  v_pk_fma_f32 v[234:235], v[42:43], v[42:43], v[234:235]
  v_pk_add_f32 v[232:233], v[232:233], v[44:45]
  v_pk_fma_f32 v[234:235], v[44:45], v[44:45], v[234:235]
  v_pk_add_f32 v[232:233], v[232:233], v[46:47]
  v_pk_fma_f32 v[234:235], v[46:47], v[46:47], v[234:235]
  v_add_f32 v232, v232, v233
  v_add_f32 v233, v234, v235
  v_mov_b32 v234, v232
  v_mov_b32 v235, v233
  s_nop 0
  v_permlane32_swap_b32 v232, v234
  v_permlane32_swap_b32 v233, v235
  v_pk_add_f32 v[232:233], v[232:233], v[234:235]
  s_lshl_b32 s25, s23, 12
  s_add_u32 s25, s25, s29
  s_lshl_b32 s26, s24, 8
  s_add_u32 s25, s25, s26
  v_lshlrev_b32 v13, 3, v1
  s_mov_b32 exec_hi, 0
  buffer_store_dwordx2 v[232:233], v13, s[4:7], s25 offen sc1
  s_mov_b64 exec, -1
  s_cmp_eq_u32 s12, 0
  s_cbranch_scc1 Lw_39
  s_cmp_lg_u32 s13, 0
  s_cbranch_scc1 Lcd_40
  s_mul_i32 s20, s19, 236544
  s_add_u32 s20, s20, 3145728
  s_sub_u32 s21, s12, 1
  s_mul_i32 s21, s21, 2
  s_add_u32 s21, s21, 0
  s_min_u32 s21, s21, 4
  s_add_u32 s22, s21, 0
  s_lshr_b32 s23, s22, 3
  s_mul_i32 s23, s23, 33792
  s_and_b32 s24, s22, 7
  s_lshl_b32 s24, s24, 12
  s_add_u32 s23, s23, s24
  s_add_u32 s23, s23, s20
  s_lshl_b32 s24, s22, 12
  s_add_u32 m0, s24, 65536
  s_nop 0
  buffer_load_dwordx4 v2, s[4:7], s23 offen offset:0 sc1 lds
  buffer_load_dwordx4 v2, s[4:7], s23 offen offset:1024 sc1 lds
  buffer_load_dwordx4 v2, s[4:7], s23 offen offset:2048 sc1 lds
  buffer_load_dwordx4 v2, s[4:7], s23 offen offset:3072 sc1 lds
  s_add_u32 s22, s21, 1
  s_lshr_b32 s23, s22, 3
  s_mul_i32 s23, s23, 33792
  s_and_b32 s24, s22, 7
  s_lshl_b32 s24, s24, 12
  s_add_u32 s23, s23, s24
  s_add_u32 s23, s23, s20
  s_lshl_b32 s24, s22, 12
  s_add_u32 m0, s24, 65536
  s_nop 0
  buffer_load_dwordx4 v2, s[4:7], s23 offen offset:0 sc1 lds
  buffer_load_dwordx4 v2, s[4:7], s23 offen offset:1024 sc1 lds
  buffer_load_dwordx4 v2, s[4:7], s23 offen offset:2048 sc1 lds
  buffer_load_dwordx4 v2, s[4:7], s23 offen offset:3072 sc1 lds
  s_waitcnt vmcnt(8)
  s_branch Lcde_41
Lcd_40:
  s_waitcnt vmcnt(0)
Lcde_41:
Lw_39:
  s_cmp_lg_u32 s12, 0
  s_cbranch_scc1 Lw_42
  s_waitcnt vmcnt(0)
Lw_42:
  s_barrier
  s_cmp_lg_u32 s12, 0
  s_cbranch_scc1 Lw_43
  s_lshl_b32 s39, s13, 3
  s_add_u32 s39, s39, 5
  s_lshl_b32 s38, s2, 7
  v_mov_b32 v214, s38
  v_mov_b32 v215, s39
  s_mov_b64 exec, 1
  buffer_store_dword v215, v214, s[4:7], 0 offen offset:0 sc1
  s_mov_b64 exec, -1
Lw_43:
  s_cmp_eq_u32 s12, 0
  s_cbranch_scc1 Lw_44
  s_cmp_lg_u32 s13, 0
  s_cbranch_scc1 Lx1p_45
  s_mul_i32 s20, s19, 236544
  s_add_u32 s20, s20, 3145728
  s_sub_u32 s21, s12, 1
  s_mul_i32 s21, s21, 6
  s_add_u32 s21, s21, 6
  s_min_u32 s21, s21, 18
  s_add_u32 s22, s21, 0
  s_lshr_b32 s23, s22, 3
  s_mul_i32 s23, s23, 33792
  s_and_b32 s24, s22, 7
  s_lshl_b32 s24, s24, 12
  s_add_u32 s23, s23, s24
  s_add_u32 s23, s23, s20
  s_lshl_b32 s24, s22, 12
  s_add_u32 m0, s24, 65536
  s_nop 0
  buffer_load_dwordx4 v2, s[4:7], s23 offen offset:0 sc1 lds
  buffer_load_dwordx4 v2, s[4:7], s23 offen offset:1024 sc1 lds
  buffer_load_dwordx4 v2, s[4:7], s23 offen offset:2048 sc1 lds
  buffer_load_dwordx4 v2, s[4:7], s23 offen offset:3072 sc1 lds
  s_add_u32 s22, s21, 1
  s_lshr_b32 s23, s22, 3
  s_mul_i32 s23, s23, 33792
  s_and_b32 s24, s22, 7
  s_lshl_b32 s24, s24, 12
  s_add_u32 s23, s23, s24
  s_add_u32 s23, s23, s20
  s_lshl_b32 s24, s22, 12
  s_add_u32 m0, s24, 65536
  s_nop 0
  buffer_load_dwordx4 v2, s[4:7], s23 offen offset:0 sc1 lds
  buffer_load_dwordx4 v2, s[4:7], s23 offen offset:1024 sc1 lds
  buffer_load_dwordx4 v2, s[4:7], s23 offen offset:2048 sc1 lds
  buffer_load_dwordx4 v2, s[4:7], s23 offen offset:3072 sc1 lds
  s_add_u32 s22, s21, 2
  s_lshr_b32 s23, s22, 3
  s_mul_i32 s23, s23, 33792
  s_and_b32 s24, s22, 7
  s_lshl_b32 s24, s24, 12
  s_add_u32 s23, s23, s24
  s_add_u32 s23, s23, s20
  s_lshl_b32 s24, s22, 12
  s_add_u32 m0, s24, 65536
  s_nop 0
  buffer_load_dwordx4 v2, s[4:7], s23 offen offset:0 sc1 lds
  buffer_load_dwordx4 v2, s[4:7], s23 offen offset:1024 sc1 lds
  buffer_load_dwordx4 v2, s[4:7], s23 offen offset:2048 sc1 lds
  buffer_load_dwordx4 v2, s[4:7], s23 offen offset:3072 sc1 lds
  s_add_u32 s22, s21, 3
  s_lshr_b32 s23, s22, 3
  s_mul_i32 s23, s23, 33792
  s_and_b32 s24, s22, 7
  s_lshl_b32 s24, s24, 12
  s_add_u32 s23, s23, s24
  s_add_u32 s23, s23, s20
  s_lshl_b32 s24, s22, 12
  s_add_u32 m0, s24, 65536
  s_nop 0
  buffer_load_dwordx4 v2, s[4:7], s23 offen offset:0 sc1 lds
  buffer_load_dwordx4 v2, s[4:7], s23 offen offset:1024 sc1 lds
  buffer_load_dwordx4 v2, s[4:7], s23 offen offset:2048 sc1 lds
  buffer_load_dwordx4 v2, s[4:7], s23 offen offset:3072 sc1 lds
  s_add_u32 s22, s21, 4
  s_lshr_b32 s23, s22, 3
  s_mul_i32 s23, s23, 33792
  s_and_b32 s24, s22, 7
  s_lshl_b32 s24, s24, 12
  s_add_u32 s23, s23, s24
  s_add_u32 s23, s23, s20
  s_lshl_b32 s24, s22, 12
  s_add_u32 m0, s24, 65536
  s_nop 0
  buffer_load_dwordx4 v2, s[4:7], s23 offen offset:0 sc1 lds
  buffer_load_dwordx4 v2, s[4:7], s23 offen offset:1024 sc1 lds
  buffer_load_dwordx4 v2, s[4:7], s23 offen offset:2048 sc1 lds
  buffer_load_dwordx4 v2, s[4:7], s23 offen offset:3072 sc1 lds
  s_add_u32 s22, s21, 5
  s_lshr_b32 s23, s22, 3
  s_mul_i32 s23, s23, 33792
  s_and_b32 s24, s22, 7
  s_lshl_b32 s24, s24, 12
  s_add_u32 s23, s23, s24
  s_add_u32 s23, s23, s20
  s_lshl_b32 s24, s22, 12
  s_add_u32 m0, s24, 65536
  s_nop 0
  buffer_load_dwordx4 v2, s[4:7], s23 offen offset:0 sc1 lds
  buffer_load_dwordx4 v2, s[4:7], s23 offen offset:1024 sc1 lds
  buffer_load_dwordx4 v2, s[4:7], s23 offen offset:2048 sc1 lds
  buffer_load_dwordx4 v2, s[4:7], s23 offen offset:3072 sc1 lds
Lx1p_45:
  s_mul_i32 s20, s19, 236544
  s_add_u32 s20, s20, 3247104
  s_sub_u32 s21, s12, 1
  s_mul_i32 s21, s21, 6
  s_add_u32 s21, s21, 0
  s_min_u32 s21, s21, 10
  s_add_u32 s22, s21, 0
  s_lshr_b32 s23, s22, 3
  s_mul_i32 s23, s23, 33792
  s_and_b32 s24, s22, 7
  s_lshl_b32 s24, s24, 12
  s_add_u32 s23, s23, s24
  s_add_u32 s23, s23, s20
  s_lshl_b32 s24, s22, 12
  s_add_u32 m0, s24, 0
  s_nop 0
  buffer_load_dwordx4 v2, s[4:7], s23 offen offset:0 sc1 lds
  buffer_load_dwordx4 v2, s[4:7], s23 offen offset:1024 sc1 lds
  buffer_load_dwordx4 v2, s[4:7], s23 offen offset:2048 sc1 lds
  buffer_load_dwordx4 v2, s[4:7], s23 offen offset:3072 sc1 lds
  s_add_u32 s22, s21, 1
  s_lshr_b32 s23, s22, 3
  s_mul_i32 s23, s23, 33792
  s_and_b32 s24, s22, 7
  s_lshl_b32 s24, s24, 12
  s_add_u32 s23, s23, s24
  s_add_u32 s23, s23, s20
  s_lshl_b32 s24, s22, 12
  s_add_u32 m0, s24, 0
  s_nop 0
  buffer_load_dwordx4 v2, s[4:7], s23 offen offset:0 sc1 lds
  buffer_load_dwordx4 v2, s[4:7], s23 offen offset:1024 sc1 lds
  buffer_load_dwordx4 v2, s[4:7], s23 offen offset:2048 sc1 lds
  buffer_load_dwordx4 v2, s[4:7], s23 offen offset:3072 sc1 lds
  s_add_u32 s22, s21, 2
  s_lshr_b32 s23, s22, 3
  s_mul_i32 s23, s23, 33792
  s_and_b32 s24, s22, 7
  s_lshl_b32 s24, s24, 12
  s_add_u32 s23, s23, s24
  s_add_u32 s23, s23, s20
  s_lshl_b32 s24, s22, 12
  s_add_u32 m0, s24, 0
  s_nop 0
  buffer_load_dwordx4 v2, s[4:7], s23 offen offset:0 sc1 lds
  buffer_load_dwordx4 v2, s[4:7], s23 offen offset:1024 sc1 lds
  buffer_load_dwordx4 v2, s[4:7], s23 offen offset:2048 sc1 lds
  buffer_load_dwordx4 v2, s[4:7], s23 offen offset:3072 sc1 lds
  s_add_u32 s22, s21, 3
  s_lshr_b32 s23, s22, 3
  s_mul_i32 s23, s23, 33792
  s_and_b32 s24, s22, 7
  s_lshl_b32 s24, s24, 12
  s_add_u32 s23, s23, s24
  s_add_u32 s23, s23, s20
  s_lshl_b32 s24, s22, 12
  s_add_u32 m0, s24, 0
  s_nop 0
  buffer_load_dwordx4 v2, s[4:7], s23 offen offset:0 sc1 lds
  buffer_load_dwordx4 v2, s[4:7], s23 offen offset:1024 sc1 lds
  buffer_load_dwordx4 v2, s[4:7], s23 offen offset:2048 sc1 lds
  buffer_load_dwordx4 v2, s[4:7], s23 offen offset:3072 sc1 lds
  s_add_u32 s22, s21, 4
  s_lshr_b32 s23, s22, 3
  s_mul_i32 s23, s23, 33792
  s_and_b32 s24, s22, 7
  s_lshl_b32 s24, s24, 12
  s_add_u32 s23, s23, s24
  s_add_u32 s23, s23, s20
  s_lshl_b32 s24, s22, 12
  s_add_u32 m0, s24, 0
  s_nop 0
  buffer_load_dwordx4 v2, s[4:7], s23 offen offset:0 sc1 lds
  buffer_load_dwordx4 v2, s[4:7], s23 offen offset:1024 sc1 lds
  buffer_load_dwordx4 v2, s[4:7], s23 offen offset:2048 sc1 lds
  buffer_load_dwordx4 v2, s[4:7], s23 offen offset:3072 sc1 lds
  s_add_u32 s22, s21, 5
  s_lshr_b32 s23, s22, 3
  s_mul_i32 s23, s23, 33792
  s_and_b32 s24, s22, 7
  s_lshl_b32 s24, s24, 12
  s_add_u32 s23, s23, s24
  s_add_u32 s23, s23, s20
  s_lshl_b32 s24, s22, 12
  s_add_u32 m0, s24, 0
  s_nop 0
  buffer_load_dwordx4 v2, s[4:7], s23 offen offset:0 sc1 lds
  buffer_load_dwordx4 v2, s[4:7], s23 offen offset:1024 sc1 lds
  buffer_load_dwordx4 v2, s[4:7], s23 offen offset:2048 sc1 lds
  buffer_load_dwordx4 v2, s[4:7], s23 offen offset:3072 sc1 lds
Lw_44:
  s_mul_i32 s66, s19, 236544
  s_add_u32 s66, s66, 3145728
  s_add_u32 s22, s66, 32768
  buffer_load_dwordx4 v[124:127], v2, s[4:7], s22 offen offset:0 sc1
  s_add_u32 s22, s66, 66560
  buffer_load_dwordx4 v[128:131], v2, s[4:7], s22 offen offset:0 sc1
  s_add_u32 s22, s66, 100352
  buffer_load_dwordx4 v[132:135], v2, s[4:7], s22 offen offset:0 sc1
  s_add_u32 s22, s66, 134144
  buffer_load_dwordx4 v[136:139], v2, s[4:7], s22 offen offset:0 sc1
  s_add_u32 s22, s66, 167936
  buffer_load_dwordx4 v[140:143], v2, s[4:7], s22 offen offset:0 sc1
  s_add_u32 s22, s66, 201728
  buffer_load_dwordx4 v[144:147], v2, s[4:7], s22 offen offset:0 sc1
  s_add_u32 s22, s66, 235520
  buffer_load_dwordx4 v[148:151], v2, s[4:7], s22 offen offset:0 sc1
  s_cmp_lg_u32 s12, 0
  s_cbranch_scc1 Lw_46
  v_and_b32 v215, 15, v1
  s_lshl_b32 s36, s18, 1
  v_lshrrev_b32 v214, 3, v215
  v_add_u32 v214, s36, v214
  v_and_b32 v215, 7, v215
  v_lshlrev_b32 v215, 3, v215
  v_and_b32 v216, 3, v214
  v_lshl_add_u32 v215, v216, 6, v215
  v_lshrrev_b32 v214, 2, v214
  v_add_u32 v214, v214, v215
  v_lshlrev_b32 v214, 7, v214
  s_lshl_b32 s39, s13, 3
  s_add_u32 s39, s39, 5
  s_mov_b32 s38, 0
  buffer_load_dword v210, v214, s[4:7], 0 offen sc1
  buffer_load_dword v212, v214, s[4:7], 0 offen sc1
Lpoll_47:
  s_waitcnt vmcnt(1)
  v_cmp_gt_u32 vcc, s39, v210
  s_nop 4
  s_cbranch_vccz Lpolld_48
  buffer_load_dword v210, v214, s[4:7], 0 offen sc1
  s_waitcnt vmcnt(1)
  v_cmp_gt_u32 vcc, s39, v212
  s_nop 4
  s_cbranch_vccz Lpolld_48
  buffer_load_dword v212, v214, s[4:7], 0 offen sc1
  s_add_u32 s38, s38, 1
  s_cmp_le_u32 s38, 200000
  s_cbranch_scc1 Lpoll_47
Lpolld_48:
Lw_46:
  s_barrier
  s_lshl_b32 s23, s18, 2
  s_add_u32 s23, s23, s12
  s_cmp_eq_u32 s13, 0
  s_mov_b32 s24, 0x1000000
  s_cselect_b32 s24, 0xc00000, s24
  s_lshl_b32 s25, s23, 15
  s_add_u32 s24, s24, s25
  buffer_load_dwordx4 a[0:3], v2, s[4:7], s24 offen offset:0 sc1
  buffer_load_dwordx4 a[4:7], v2, s[4:7], s24 offen offset:1024 sc1
  buffer_load_dwordx4 a[8:11], v2, s[4:7], s24 offen offset:2048 sc1
  buffer_load_dwordx4 a[12:15], v2, s[4:7], s24 offen offset:3072 sc1
  s_add_u32 s24, s24, 4096
  buffer_load_dwordx4 a[16:19], v2, s[4:7], s24 offen offset:0 sc1
  buffer_load_dwordx4 a[20:23], v2, s[4:7], s24 offen offset:1024 sc1
  buffer_load_dwordx4 a[24:27], v2, s[4:7], s24 offen offset:2048 sc1
  buffer_load_dwordx4 a[28:31], v2, s[4:7], s24 offen offset:3072 sc1
  s_add_u32 s24, s24, 4096
  buffer_load_dwordx4 a[32:35], v2, s[4:7], s24 offen offset:0 sc1
  buffer_load_dwordx4 a[36:39], v2, s[4:7], s24 offen offset:1024 sc1
  s_cmp_eq_u32 s13, 0
  s_mov_b32 s27, 0x12c0000
  s_cselect_b32 s27, 0x1240000, s27
  s_lshl_b32 s25, s23, 12
  s_add_u32 s27, s27, s25
  v_lshrrev_b32 v15, 5, v1
  v_lshlrev_b32 v15, 11, v15
  v_and_b32 v14, 31, v1
  v_lshl_add_u32 v15, v14, 3, v15
  buffer_load_dwordx2 v[152:153], v15, s[4:7], s27 offen offset:0 sc1
  buffer_load_dwordx2 v[154:155], v15, s[4:7], s27 offen offset:256 sc1
  buffer_load_dwordx2 v[156:157], v15, s[4:7], s27 offen offset:512 sc1
  buffer_load_dwordx2 v[158:159], v15, s[4:7], s27 offen offset:768 sc1
  buffer_load_dwordx2 v[160:161], v15, s[4:7], s27 offen offset:1024 sc1
  buffer_load_dwordx2 v[162:163], v15, s[4:7], s27 offen offset:1280 sc1
  buffer_load_dwordx2 v[164:165], v15, s[4:7], s27 offen offset:1536 sc1
  buffer_load_dwordx2 v[166:167], v15, s[4:7], s27 offen offset:1792 sc1
  s_cmp_eq_u32 s13, 0
  s_mov_b32 s67, 0x2300000
  s_cselect_b32 s67, 0x1b00000, s67
  s_mul_i32 s25, s23, 114688
  s_add_u32 s67, s67, s25
  s_mul_i32 s25, s19, 7168
  s_add_u32 s67, s67, s25
  s_mul_i32 s33, s17, 229376
  s_mul_i32 s34, s12, 57344
  s_add_u32 s33, s33, s34
  s_add_u32 s33, s33, 8388608
  s_and_b32 s21, s12, 1
  s_xor_b32 s22, s21, 0
  s_lshl_b32 s22, s22, 10
  s_add_u32 s34, s33, s22
  s_xor_b32 s22, s21, 1
  s_lshl_b32 s22, s22, 10
  s_add_u32 s35, s33, s22
  v_add_u32 v26, 0x20000, v2
  s_waitcnt vmcnt(25)
  s_barrier
  ds_read_b128 v[84:87], v3 offset:0
  ds_read_b128 v[88:91], v3 offset:32768
  ds_read_b128 v[92:95], v3 offset:1024
  ds_read_b128 v[96:99], v3 offset:33792
  ds_read_b128 v[100:103], v3 offset:2048
  ds_read_b128 v[104:107], v3 offset:34816
  s_waitcnt lgkmcnt(4)
  s_waitcnt vmcnt(17)
  v_mfma_f32_32x32x16_bf16 v[36:51], v[84:87], a[0:3], 0
  ds_read_b128 v[108:111], v3 offset:3072
  v_mfma_f32_32x32x16_bf16 v[52:67], v[88:91], a[0:3], 0
  ds_read_b128 v[112:115], v3 offset:35840
  buffer_load_dwordx4 a[40:43], v2, s[4:7], s24 offen offset:2048 sc1
  s_waitcnt lgkmcnt(4)
  s_waitcnt vmcnt(17)
  v_mfma_f32_32x32x16_bf16 v[36:51], v[92:95], a[4:7], v[36:51]
  ds_read_b128 v[84:87], v3 offset:4096
  v_mfma_f32_32x32x16_bf16 v[52:67], v[96:99], a[4:7], v[52:67]
  ds_read_b128 v[88:91], v3 offset:36864
  buffer_load_dwordx4 a[44:47], v2, s[4:7], s24 offen offset:3072 sc1
  s_waitcnt lgkmcnt(4)
  s_waitcnt vmcnt(17)
  v_mfma_f32_32x32x16_bf16 v[36:51], v[100:103], a[8:11], v[36:51]
  ds_read_b128 v[92:95], v3 offset:5120
  v_mfma_f32_32x32x16_bf16 v[52:67], v[104:107], a[8:11], v[52:67]
  ds_read_b128 v[96:99], v3 offset:37888
  s_add_u32 s24, s24, 4096
  buffer_load_dwordx4 a[48:51], v2, s[4:7], s24 offen offset:0 sc1
  s_waitcnt lgkmcnt(4)
  s_waitcnt vmcnt(17)
  v_mfma_f32_32x32x16_bf16 v[36:51], v[108:111], a[12:15], v[36:51]
  ds_read_b128 v[100:103], v3 offset:6144
  v_mfma_f32_32x32x16_bf16 v[52:67], v[112:115], a[12:15], v[52:67]
  ds_read_b128 v[104:107], v3 offset:38912
  buffer_load_dwordx4 a[52:55], v2, s[4:7], s24 offen offset:1024 sc1
  s_waitcnt lgkmcnt(4)
  s_waitcnt vmcnt(17)
  v_mfma_f32_32x32x16_bf16 v[36:51], v[84:87], a[16:19], v[36:51]
  ds_read_b128 v[108:111], v3 offset:7168
  v_mfma_f32_32x32x16_bf16 v[52:67], v[88:91], a[16:19], v[52:67]
  ds_read_b128 v[112:115], v3 offset:39936
  buffer_load_dwordx4 a[56:59], v2, s[4:7], s24 offen offset:2048 sc1
  s_waitcnt lgkmcnt(4)
  s_waitcnt vmcnt(17)
  v_mfma_f32_32x32x16_bf16 v[36:51], v[92:95], a[20:23], v[36:51]
  ds_read_b128 v[84:87], v3 offset:8192
  v_mfma_f32_32x32x16_bf16 v[52:67], v[96:99], a[20:23], v[52:67]
  ds_read_b128 v[88:91], v3 offset:40960
  buffer_load_dwordx4 a[60:63], v2, s[4:7], s24 offen offset:3072 sc1
  s_waitcnt lgkmcnt(4)
  s_waitcnt vmcnt(17)
  v_mfma_f32_32x32x16_bf16 v[36:51], v[100:103], a[24:27], v[36:51]
  ds_read_b128 v[92:95], v3 offset:9216
  v_mfma_f32_32x32x16_bf16 v[52:67], v[104:107], a[24:27], v[52:67]
  ds_read_b128 v[96:99], v3 offset:41984
  s_add_u32 s24, s24, 4096
  buffer_load_dwordx4 a[64:67], v2, s[4:7], s24 offen offset:0 sc1
  s_waitcnt lgkmcnt(4)
  s_waitcnt vmcnt(17)
  v_mfma_f32_32x32x16_bf16 v[36:51], v[108:111], a[28:31], v[36:51]
  ds_read_b128 v[100:103], v3 offset:10240
  v_mfma_f32_32x32x16_bf16 v[52:67], v[112:115], a[28:31], v[52:67]
  ds_read_b128 v[104:107], v3 offset:43008
  buffer_load_dwordx4 a[68:71], v2, s[4:7], s24 offen offset:1024 sc1
  s_waitcnt lgkmcnt(4)
  s_waitcnt vmcnt(17)
  v_mfma_f32_32x32x16_bf16 v[36:51], v[84:87], a[32:35], v[36:51]
  ds_read_b128 v[108:111], v3 offset:11264
  v_mfma_f32_32x32x16_bf16 v[52:67], v[88:91], a[32:35], v[52:67]
  ds_read_b128 v[112:115], v3 offset:44032
  buffer_load_dwordx4 a[72:75], v2, s[4:7], s24 offen offset:2048 sc1
  s_waitcnt lgkmcnt(4)
  s_waitcnt vmcnt(17)
  v_mfma_f32_32x32x16_bf16 v[36:51], v[92:95], a[36:39], v[36:51]
  ds_read_b128 v[84:87], v3 offset:12288
  v_mfma_f32_32x32x16_bf16 v[52:67], v[96:99], a[36:39], v[52:67]
  ds_read_b128 v[88:91], v3 offset:45056
  buffer_load_dwordx4 a[76:79], v2, s[4:7], s24 offen offset:3072 sc1
  s_waitcnt lgkmcnt(4)
  s_waitcnt vmcnt(9)
  v_mfma_f32_32x32x16_bf16 v[36:51], v[100:103], a[40:43], v[36:51]
  ds_read_b128 v[92:95], v3 offset:13312
  v_add_f32 v152, v152, v154
  v_add_f32 v153, v153, v155
  v_mfma_f32_32x32x16_bf16 v[52:67], v[104:107], a[40:43], v[52:67]
  ds_read_b128 v[96:99], v3 offset:46080
  s_add_u32 s24, s24, 4096
  buffer_load_dwordx4 a[80:83], v2, s[4:7], s24 offen offset:0 sc1
  s_waitcnt lgkmcnt(4)
  s_waitcnt vmcnt(9)
  v_mfma_f32_32x32x16_bf16 v[36:51], v[108:111], a[44:47], v[36:51]
  ds_read_b128 v[100:103], v3 offset:14336
  v_add_f32 v152, v152, v156
  v_mfma_f32_32x32x16_bf16 v[52:67], v[112:115], a[44:47], v[52:67]
  ds_read_b128 v[104:107], v3 offset:47104
  buffer_load_dwordx4 a[84:87], v2, s[4:7], s24 offen offset:1024 sc1
  s_waitcnt lgkmcnt(4)
  v_add_f32 v153, v153, v157
  s_waitcnt vmcnt(9)
  v_mfma_f32_32x32x16_bf16 v[36:51], v[84:87], a[48:51], v[36:51]
  ds_read_b128 v[108:111], v3 offset:15360
  v_add_f32 v152, v152, v158
  v_mfma_f32_32x32x16_bf16 v[52:67], v[88:91], a[48:51], v[52:67]
  ds_read_b128 v[112:115], v3 offset:48128
  buffer_load_dwordx4 a[88:91], v2, s[4:7], s24 offen offset:2048 sc1
  s_waitcnt lgkmcnt(4)
  s_waitcnt vmcnt(9)
  v_mfma_f32_32x32x16_bf16 v[36:51], v[92:95], a[52:55], v[36:51]
  ds_read_b128 v[84:87], v3 offset:16384
  v_add_f32 v153, v153, v159
  v_add_f32 v152, v152, v160
  v_mfma_f32_32x32x16_bf16 v[52:67], v[96:99], a[52:55], v[52:67]
  ds_read_b128 v[88:91], v3 offset:49152
  buffer_load_dwordx4 a[92:95], v2, s[4:7], s24 offen offset:3072 sc1
  s_waitcnt lgkmcnt(4)
  s_waitcnt vmcnt(9)
  v_mfma_f32_32x32x16_bf16 v[36:51], v[100:103], a[56:59], v[36:51]
  ds_read_b128 v[92:95], v3 offset:17408
  v_add_f32 v153, v153, v161
  v_add_f32 v152, v152, v162
  v_mfma_f32_32x32x16_bf16 v[52:67], v[104:107], a[56:59], v[52:67]
  ds_read_b128 v[96:99], v3 offset:50176
  s_add_u32 s24, s24, 4096
  buffer_load_dwordx4 a[96:99], v2, s[4:7], s24 offen offset:0 sc1
  s_waitcnt lgkmcnt(4)
  s_waitcnt vmcnt(9)
  v_mfma_f32_32x32x16_bf16 v[36:51], v[108:111], a[60:63], v[36:51]
  ds_read_b128 v[100:103], v3 offset:18432
  v_add_f32 v153, v153, v163
  v_add_f32 v152, v152, v164
  v_mfma_f32_32x32x16_bf16 v[52:67], v[112:115], a[60:63], v[52:67]
  ds_read_b128 v[104:107], v3 offset:51200
  buffer_load_dwordx4 a[100:103], v2, s[4:7], s24 offen offset:1024 sc1
  s_waitcnt lgkmcnt(4)
  s_waitcnt vmcnt(9)
  v_mfma_f32_32x32x16_bf16 v[36:51], v[84:87], a[64:67], v[36:51]
  ds_read_b128 v[108:111], v3 offset:19456
  v_add_f32 v153, v153, v165
  v_mfma_f32_32x32x16_bf16 v[52:67], v[88:91], a[64:67], v[52:67]
  ds_read_b128 v[112:115], v3 offset:52224
  buffer_load_dwordx4 a[104:107], v2, s[4:7], s24 offen offset:2048 sc1
  s_waitcnt lgkmcnt(4)
  s_waitcnt vmcnt(9)
  v_mfma_f32_32x32x16_bf16 v[36:51], v[92:95], a[68:71], v[36:51]
  ds_read_b128 v[84:87], v3 offset:20480
  v_add_f32 v152, v152, v166
  v_add_f32 v153, v153, v167
  v_mfma_f32_32x32x16_bf16 v[52:67], v[96:99], a[68:71], v[52:67]
  ds_read_b128 v[88:91], v3 offset:53248
  buffer_load_dwordx4 a[108:111], v2, s[4:7], s24 offen offset:3072 sc1
  s_waitcnt lgkmcnt(4)
  s_waitcnt vmcnt(9)
  v_mfma_f32_32x32x16_bf16 v[36:51], v[100:103], a[72:75], v[36:51]
  ds_read_b128 v[92:95], v3 offset:21504
  v_mov_b32 v154, v152
  v_mov_b32 v155, v153
  v_mfma_f32_32x32x16_bf16 v[52:67], v[104:107], a[72:75], v[52:67]
  ds_read_b128 v[96:99], v3 offset:54272
  s_add_u32 s24, s24, 4096
  buffer_load_dwordx4 a[112:115], v2, s[4:7], s24 offen offset:0 sc1
  s_waitcnt lgkmcnt(4)
  s_waitcnt vmcnt(9)
  v_mfma_f32_32x32x16_bf16 v[36:51], v[108:111], a[76:79], v[36:51]
  ds_read_b128 v[100:103], v3 offset:22528
  v_permlane32_swap_b32 v152, v154
  v_mfma_f32_32x32x16_bf16 v[52:67], v[112:115], a[76:79], v[52:67]
  ds_read_b128 v[104:107], v3 offset:55296
  buffer_load_dwordx4 a[116:119], v2, s[4:7], s24 offen offset:1024 sc1
  s_waitcnt lgkmcnt(4)
  s_waitcnt vmcnt(9)
  v_mfma_f32_32x32x16_bf16 v[36:51], v[84:87], a[80:83], v[36:51]
  ds_read_b128 v[108:111], v3 offset:23552
  v_permlane32_swap_b32 v153, v155
  v_mfma_f32_32x32x16_bf16 v[52:67], v[88:91], a[80:83], v[52:67]
  ds_read_b128 v[112:115], v3 offset:56320
  buffer_load_dwordx4 a[120:123], v2, s[4:7], s24 offen offset:2048 sc1
  s_waitcnt lgkmcnt(4)
  s_waitcnt vmcnt(9)
  v_mfma_f32_32x32x16_bf16 v[36:51], v[92:95], a[84:87], v[36:51]
  ds_read_b128 v[84:87], v3 offset:24576
  v_add_f32 v152, v152, v154
  v_mfma_f32_32x32x16_bf16 v[52:67], v[96:99], a[84:87], v[52:67]
  ds_read_b128 v[88:91], v3 offset:57344
  buffer_load_dwordx4 a[124:127], v2, s[4:7], s24 offen offset:3072 sc1
  s_waitcnt lgkmcnt(4)
  v_add_f32 v153, v153, v155
  s_waitcnt vmcnt(9)
  v_mfma_f32_32x32x16_bf16 v[36:51], v[100:103], a[88:91], v[36:51]
  ds_read_b128 v[92:95], v3 offset:25600
  v_mul_f32 v152, 0x3b000000, v152
  v_mfma_f32_32x32x16_bf16 v[52:67], v[104:107], a[88:91], v[52:67]
  ds_read_b128 v[96:99], v3 offset:58368
  s_waitcnt lgkmcnt(4)
  v_mul_f32 v153, 0x3b000000, v153
  v_fma_f32 v153, -v152, v152, v153
  s_waitcnt vmcnt(8)
  v_mfma_f32_32x32x16_bf16 v[36:51], v[108:111], a[92:95], v[36:51]
  ds_read_b128 v[100:103], v3 offset:26624
  v_max_f32 v153, 0, v153
  v_mfma_f32_32x32x16_bf16 v[52:67], v[112:115], a[92:95], v[52:67]
  ds_read_b128 v[104:107], v3 offset:59392
  s_waitcnt lgkmcnt(4)
  v_add_f32 v153, 0x3727c5ac, v153
  s_waitcnt vmcnt(7)
  v_mfma_f32_32x32x16_bf16 v[36:51], v[84:87], a[96:99], v[36:51]
  ds_read_b128 v[108:111], v3 offset:27648
  v_rsq_f32 v12, v153
  v_mfma_f32_32x32x16_bf16 v[52:67], v[88:91], a[96:99], v[52:67]
  ds_read_b128 v[112:115], v3 offset:60416
  s_waitcnt lgkmcnt(4)
  v_sub_f32 v152, 0, v152
  v_cvt_pk_bf16_f32 v16, v152, v152
  s_waitcnt vmcnt(6)
  v_mfma_f32_32x32x16_bf16 v[36:51], v[92:95], a[100:103], v[36:51]
  ds_read_b128 v[84:87], v3 offset:28672
  v_mov_b32 v17, v16
  v_mfma_f32_32x32x16_bf16 v[52:67], v[96:99], a[100:103], v[52:67]
  ds_read_b128 v[88:91], v3 offset:61440
  s_waitcnt lgkmcnt(4)
  v_mov_b32 v18, v16
  v_mov_b32 v19, v16
  s_waitcnt vmcnt(5)
  v_mfma_f32_32x32x16_bf16 v[36:51], v[100:103], a[104:107], v[36:51]
  ds_read_b128 v[92:95], v3 offset:29696
  v_mul_f32 v14, s62, v12
  v_mfma_f32_32x32x16_bf16 v[52:67], v[104:107], a[104:107], v[52:67]
  ds_read_b128 v[96:99], v3 offset:62464
  s_waitcnt lgkmcnt(4)
  v_sub_f32 v14, 0, v14
  v_mul_f32 v24, v12, v12
  s_waitcnt vmcnt(4)
  v_mfma_f32_32x32x16_bf16 v[36:51], v[108:111], a[108:111], v[36:51]
  ds_read_b128 v[100:103], v3 offset:30720
  v_rcp_f32 v24, v24
  v_mfma_f32_32x32x16_bf16 v[52:67], v[112:115], a[108:111], v[52:67]
  ds_read_b128 v[104:107], v3 offset:63488
  s_waitcnt lgkmcnt(4)
  s_waitcnt vmcnt(3)
  v_mfma_f32_32x32x16_bf16 v[36:51], v[84:87], a[112:115], v[36:51]
  ds_read_b128 v[108:111], v3 offset:31744
  v_mfma_f32_32x32x16_bf16 v[52:67], v[88:91], a[112:115], v[52:67]
  ds_read_b128 v[112:115], v3 offset:64512
  s_waitcnt vmcnt(2) lgkmcnt(5)
  v_mfma_f32_32x32x16_bf16 v[36:51], v[92:95], a[116:119], v[36:51]
  s_waitcnt lgkmcnt(4)
  v_mfma_f32_32x32x16_bf16 v[52:67], v[96:99], a[116:119], v[52:67]
  s_waitcnt vmcnt(1) lgkmcnt(3)
  v_mfma_f32_32x32x16_bf16 v[36:51], v[100:103], a[120:123], v[36:51]
  s_waitcnt lgkmcnt(2)
  v_mfma_f32_32x32x16_bf16 v[52:67], v[104:107], a[120:123], v[52:67]
  s_waitcnt vmcnt(0) lgkmcnt(1)
  v_mfma_f32_32x32x16_bf16 v[36:51], v[108:111], a[124:127], v[36:51]
  s_waitcnt lgkmcnt(0)
  v_mfma_f32_32x32x16_bf16 v[52:67], v[112:115], a[124:127], v[52:67]
  v_mfma_f32_32x32x16_bf16 v[36:51], v[124:127], v[16:19], v[36:51]
  v_mfma_f32_32x32x16_bf16 v[52:67], v[128:131], v[16:19], v[52:67]
  ds_read_b128 v[84:87], v26 offset:0
  ds_read_b128 v[88:91], v26 offset:1024
  ds_read_b128 v[92:95], v26 offset:2048
  ds_read_b128 v[96:99], v26 offset:3072
  ds_read_b128 v[100:103], v26 offset:4096
  ds_read_b128 v[104:107], v26 offset:5120
  ds_read_b128 v[108:111], v26 offset:6144
  ds_read_b128 v[112:115], v26 offset:7168
  s_waitcnt lgkmcnt(4)
  v_mfma_f32_32x32x16_bf16 v[68:83], v[84:87], a[0:3], 0
  ds_read_b128 v[116:119], v26 offset:8192
  v_mfma_f32_32x32x16_bf16 v[68:83], v[88:91], a[4:7], v[68:83]
  ds_read_b128 v[120:123], v26 offset:9216
  v_mfma_f32_32x32x16_bf16 v[68:83], v[92:95], a[8:11], v[68:83]
  s_barrier
  ds_read_b128 v[84:87], v26 offset:10240
  v_mfma_f32_32x32x16_bf16 v[68:83], v[96:99], a[12:15], v[68:83]
  ds_read_b128 v[88:91], v26 offset:11264
  s_waitcnt lgkmcnt(4)
  s_lshl_b32 s69, s12, 13
  s_add_u32 s70, s69, s66
  s_add_u32 s70, s70, 168960
  v_mfma_f32_32x32x16_bf16 v[68:83], v[100:103], a[16:19], v[68:83]
  ds_read_b128 v[92:95], v26 offset:12288
  s_add_u32 s69, s69, 65536
  s_add_u32 m0, s69, 0
  s_nop 0
  buffer_load_dwordx4 v2, s[4:7], s70 offen offset:0 sc1 lds
  v_mfma_f32_32x32x16_bf16 v[68:83], v[104:107], a[20:23], v[68:83]
  ds_read_b128 v[96:99], v26 offset:13312
  buffer_load_dwordx4 v2, s[4:7], s70 offen offset:1024 sc1 lds
  buffer_load_dwordx4 v2, s[4:7], s70 offen offset:2048 sc1 lds
  v_mfma_f32_32x32x16_bf16 v[68:83], v[108:111], a[24:27], v[68:83]
  ds_read_b128 v[100:103], v26 offset:14336
  buffer_load_dwordx4 v2, s[4:7], s70 offen offset:3072 sc1 lds
  s_add_u32 m0, s69, 4096
  s_add_u32 s70, s70, 4096
  v_mfma_f32_32x32x16_bf16 v[68:83], v[112:115], a[28:31], v[68:83]
  ds_read_b128 v[104:107], v26 offset:15360
  s_waitcnt lgkmcnt(4)
  buffer_load_dwordx4 v2, s[4:7], s70 offen offset:0 sc1 lds
  v_mfma_f32_32x32x16_bf16 v[68:83], v[116:119], a[32:35], v[68:83]
  ds_read_b128 v[108:111], v26 offset:16384
  buffer_load_dwordx4 v2, s[4:7], s70 offen offset:1024 sc1 lds
  buffer_load_dwordx4 v2, s[4:7], s70 offen offset:2048 sc1 lds
  v_mfma_f32_32x32x16_bf16 v[68:83], v[120:123], a[36:39], v[68:83]
  ds_read_b128 v[112:115], v26 offset:17408
  buffer_load_dwordx4 v2, s[4:7], s70 offen offset:3072 sc1 lds
  v_mul_f32 v152, v36, v14
  s_add_u32 s22, s34, 0
  v_mul_f32 v153, v37, v14
  v_mfma_f32_32x32x16_bf16 v[68:83], v[84:87], a[40:43], v[68:83]
  ds_read_b128 v[116:119], v26 offset:18432
  buffer_load_dwordx4 a[128:131], v2, s[4:7], s22 offen offset:0 sc1
  v_mul_f32 v154, v38, v14
  buffer_load_dwordx4 a[136:139], v2, s[4:7], s22 offen offset:2048 sc1
  v_mfma_f32_32x32x16_bf16 v[68:83], v[88:91], a[44:47], v[68:83]
  ds_read_b128 v[120:123], v26 offset:19456
  s_waitcnt lgkmcnt(4)
  v_mul_f32 v155, v39, v14
  s_add_u32 s22, s35, 0
  v_mul_f32 v156, v44, v14
  v_mfma_f32_32x32x16_bf16 v[68:83], v[92:95], a[48:51], v[68:83]
  ds_read_b128 v[84:87], v26 offset:20480
  buffer_load_dwordx4 a[132:135], v2, s[4:7], s22 offen offset:0 sc1
  v_mul_f32 v157, v45, v14
  v_mfma_f32_32x32x16_bf16 v[68:83], v[96:99], a[52:55], v[68:83]
  ds_read_b128 v[88:91], v26 offset:21504
  buffer_load_dwordx4 a[140:143], v2, s[4:7], s22 offen offset:2048 sc1
  v_mul_f32 v158, v46, v14
  s_add_u32 s22, s34, 4096
  v_mul_f32 v159, v47, v14
  v_mfma_f32_32x32x16_bf16 v[68:83], v[100:103], a[56:59], v[68:83]
  ds_read_b128 v[92:95], v26 offset:22528
  buffer_load_dwordx4 a[144:147], v2, s[4:7], s22 offen offset:0 sc1
  v_exp_f32 v152, v152
  v_mfma_f32_32x32x16_bf16 v[68:83], v[104:107], a[60:63], v[68:83]
  ds_read_b128 v[96:99], v26 offset:23552
  s_waitcnt lgkmcnt(4)
  buffer_load_dwordx4 a[152:155], v2, s[4:7], s22 offen offset:2048 sc1
  v_exp_f32 v153, v153
  v_mul_f32 v40, v36, v40
  v_mfma_f32_32x32x16_bf16 v[68:83], v[108:111], a[64:67], v[68:83]
  ds_read_b128 v[100:103], v26 offset:24576
  v_mul_f32 v41, v37, v41
  v_exp_f32 v154, v154
  v_exp_f32 v155, v155
  v_mfma_f32_32x32x16_bf16 v[68:83], v[112:115], a[68:71], v[68:83]
  ds_read_b128 v[104:107], v26 offset:25600
  v_mul_f32 v42, v38, v42
  v_mul_f32 v43, v39, v43
  v_exp_f32 v156, v156
  v_exp_f32 v157, v157
  v_mfma_f32_32x32x16_bf16 v[68:83], v[116:119], a[72:75], v[68:83]
  ds_read_b128 v[108:111], v26 offset:26624
  v_mul_f32 v48, v44, v48
  v_mul_f32 v49, v45, v49
  v_exp_f32 v158, v158
  v_exp_f32 v159, v159
  v_mfma_f32_32x32x16_bf16 v[68:83], v[120:123], a[76:79], v[68:83]
  ds_read_b128 v[112:115], v26 offset:27648
  s_waitcnt lgkmcnt(4)
  v_mul_f32 v50, v46, v50
  v_mul_f32 v51, v47, v51
  v_fma_f32 v152, v152, v24, v24
  v_fma_f32 v153, v153, v24, v24
  v_mfma_f32_32x32x16_bf16 v[68:83], v[84:87], a[80:83], v[68:83]
  ds_read_b128 v[116:119], v26 offset:28672
  v_fma_f32 v154, v154, v24, v24
  v_fma_f32 v155, v155, v24, v24
  v_fma_f32 v156, v156, v24, v24
  v_fma_f32 v157, v157, v24, v24
  v_fma_f32 v158, v158, v24, v24
  v_fma_f32 v159, v159, v24, v24
  v_mfma_f32_32x32x16_bf16 v[68:83], v[88:91], a[84:87], v[68:83]
  ds_read_b128 v[120:123], v26 offset:29696
  v_rcp_f32 v152, v152
  v_rcp_f32 v153, v153
  v_rcp_f32 v154, v154
  v_mfma_f32_32x32x16_bf16 v[68:83], v[92:95], a[88:91], v[68:83]
  ds_read_b128 v[84:87], v26 offset:30720
  v_rcp_f32 v155, v155
  v_rcp_f32 v156, v156
  v_rcp_f32 v157, v157
  v_mfma_f32_32x32x16_bf16 v[68:83], v[96:99], a[92:95], v[68:83]
  ds_read_b128 v[88:91], v26 offset:31744
  s_waitcnt lgkmcnt(4)
  v_rcp_f32 v158, v158
  v_rcp_f32 v159, v159
  v_mfma_f32_32x32x16_bf16 v[68:83], v[100:103], a[96:99], v[68:83]
  ds_read_b128 v[92:95], v2 offset:0
  v_mul_f32 v40, v40, v152
  v_mul_f32 v41, v41, v153
  v_mul_f32 v42, v42, v154
  v_mul_f32 v43, v43, v155
  v_mul_f32 v48, v48, v156
  v_mul_f32 v49, v49, v157
  v_mfma_f32_32x32x16_bf16 v[68:83], v[104:107], a[100:103], v[68:83]
  ds_read_b128 v[96:99], v2 offset:1024
  v_mul_f32 v50, v50, v158
  v_mul_f32 v51, v51, v159
  v_cvt_pk_bf16_f32 v160, v40, v41
  v_cvt_pk_bf16_f32 v161, v42, v43
  v_cvt_pk_bf16_f32 v162, v48, v49
  v_mfma_f32_32x32x16_bf16 v[68:83], v[108:111], a[104:107], v[68:83]
  ds_read_b128 v[100:103], v2 offset:2048
  v_cvt_pk_bf16_f32 v163, v50, v51
  s_add_u32 s68, s67, 0
  buffer_store_dwordx4 v[160:163], v2, s[4:7], s68 offen sc1
  v_mfma_f32_32x32x16_bf16 v[68:83], v[112:115], a[108:111], v[68:83]
  ds_read_b128 v[104:107], v2 offset:3072
  s_waitcnt lgkmcnt(4)
  v_mul_f32 v164, v52, v14
  v_mul_f32 v165, v53, v14
  v_mul_f32 v166, v54, v14
  v_mul_f32 v167, v55, v14
  v_mfma_f32_32x32x16_bf16 v[68:83], v[116:119], a[112:115], v[68:83]
  ds_read_b128 v[108:111], v2 offset:4096
  v_mul_f32 v168, v60, v14
  v_mul_f32 v169, v61, v14
  v_mul_f32 v170, v62, v14
  v_mul_f32 v171, v63, v14
  v_exp_f32 v164, v164
  v_mfma_f32_32x32x16_bf16 v[68:83], v[120:123], a[116:119], v[68:83]
  ds_read_b128 v[112:115], v2 offset:5120
  v_exp_f32 v165, v165
  v_mul_f32 v56, v52, v56
  v_mul_f32 v57, v53, v57
  v_exp_f32 v166, v166
  v_mfma_f32_32x32x16_bf16 v[68:83], v[84:87], a[120:123], v[68:83]
  ds_read_b128 v[116:119], v2 offset:6144
  v_exp_f32 v167, v167
  v_mul_f32 v58, v54, v58
  v_mul_f32 v59, v55, v59
  v_exp_f32 v168, v168
  v_mfma_f32_32x32x16_bf16 v[68:83], v[88:91], a[124:127], v[68:83]
  ds_read_b128 v[120:123], v2 offset:7168
  v_exp_f32 v169, v169
  v_mul_f32 v64, v60, v64
  v_mul_f32 v65, v61, v65
  v_mfma_f32_32x32x16_bf16 v[68:83], v[132:135], v[16:19], v[68:83]
  v_exp_f32 v170, v170
  v_exp_f32 v171, v171
  v_mul_f32 v66, v62, v66
  v_mul_f32 v67, v63, v67
  v_fma_f32 v164, v164, v24, v24
  v_fma_f32 v165, v165, v24, v24
  s_waitcnt lgkmcnt(4)
  v_mfma_f32_32x32x16_bf16 v[36:51], v[92:95], a[0:3], 0
  ds_read_b128 v[84:87], v2 offset:8192
  v_mfma_f32_32x32x16_bf16 v[36:51], v[96:99], a[4:7], v[36:51]
  ds_read_b128 v[88:91], v2 offset:9216
  s_lshl_b32 s69, s12, 13
  s_add_u32 s70, s69, s66
  s_add_u32 s70, s70, 202752
  s_add_u32 s69, s69, 98304
  s_add_u32 m0, s69, 0
  v_mfma_f32_32x32x16_bf16 v[36:51], v[100:103], a[8:11], v[36:51]
  ds_read_b128 v[92:95], v2 offset:10240
  buffer_load_dwordx4 v2, s[4:7], s70 offen offset:0 sc1 lds
  buffer_load_dwordx4 v2, s[4:7], s70 offen offset:1024 sc1 lds
  v_mfma_f32_32x32x16_bf16 v[36:51], v[104:107], a[12:15], v[36:51]
  ds_read_b128 v[96:99], v2 offset:11264
  s_waitcnt lgkmcnt(4)
  buffer_load_dwordx4 v2, s[4:7], s70 offen offset:2048 sc1 lds
  v_mfma_f32_32x32x16_bf16 v[36:51], v[108:111], a[16:19], v[36:51]
  ds_read_b128 v[100:103], v2 offset:12288
  buffer_load_dwordx4 v2, s[4:7], s70 offen offset:3072 sc1 lds
  s_add_u32 m0, s69, 4096
  s_add_u32 s70, s70, 4096
  v_mfma_f32_32x32x16_bf16 v[36:51], v[112:115], a[20:23], v[36:51]
  ds_read_b128 v[104:107], v2 offset:13312
  buffer_load_dwordx4 v2, s[4:7], s70 offen offset:0 sc1 lds
  buffer_load_dwordx4 v2, s[4:7], s70 offen offset:1024 sc1 lds
  v_mfma_f32_32x32x16_bf16 v[36:51], v[116:119], a[24:27], v[36:51]
  ds_read_b128 v[108:111], v2 offset:14336
  buffer_load_dwordx4 v2, s[4:7], s70 offen offset:2048 sc1 lds
  v_mfma_f32_32x32x16_bf16 v[36:51], v[120:123], a[28:31], v[36:51]
  ds_read_b128 v[112:115], v2 offset:15360
  s_waitcnt lgkmcnt(4)
  buffer_load_dwordx4 v2, s[4:7], s70 offen offset:3072 sc1 lds
  v_fma_f32 v166, v166, v24, v24
  s_add_u32 s22, s35, 4096
  v_mfma_f32_32x32x16_bf16 v[36:51], v[84:87], a[32:35], v[36:51]
  ds_read_b128 v[116:119], v2 offset:16384
  v_fma_f32 v167, v167, v24, v24
  buffer_load_dwordx4 a[148:151], v2, s[4:7], s22 offen offset:0 sc1
  v_fma_f32 v168, v168, v24, v24
  v_mfma_f32_32x32x16_bf16 v[36:51], v[88:91], a[36:39], v[36:51]
  ds_read_b128 v[120:123], v2 offset:17408
  buffer_load_dwordx4 a[156:159], v2, s[4:7], s22 offen offset:2048 sc1
  v_fma_f32 v169, v169, v24, v24
  s_add_u32 s22, s34, 8192
  v_mfma_f32_32x32x16_bf16 v[36:51], v[92:95], a[40:43], v[36:51]
  ds_read_b128 v[84:87], v2 offset:18432
  v_fma_f32 v170, v170, v24, v24
  buffer_load_dwordx4 a[160:163], v2, s[4:7], s22 offen offset:0 sc1
  v_fma_f32 v171, v171, v24, v24
  v_mfma_f32_32x32x16_bf16 v[36:51], v[96:99], a[44:47], v[36:51]
  ds_read_b128 v[88:91], v2 offset:19456
  s_waitcnt lgkmcnt(4)
  buffer_load_dwordx4 a[168:171], v2, s[4:7], s22 offen offset:2048 sc1
  v_mfma_f32_32x32x16_bf16 v[36:51], v[100:103], a[48:51], v[36:51]
  ds_read_b128 v[92:95], v2 offset:20480
  v_rcp_f32 v164, v164
  s_add_u32 s22, s35, 8192
  v_rcp_f32 v165, v165
  v_mfma_f32_32x32x16_bf16 v[36:51], v[104:107], a[52:55], v[36:51]
  ds_read_b128 v[96:99], v2 offset:21504
  buffer_load_dwordx4 a[164:167], v2, s[4:7], s22 offen offset:0 sc1
  v_rcp_f32 v166, v166
  v_mfma_f32_32x32x16_bf16 v[36:51], v[108:111], a[56:59], v[36:51]
  ds_read_b128 v[100:103], v2 offset:22528
  buffer_load_dwordx4 a[172:175], v2, s[4:7], s22 offen offset:2048 sc1
  v_rcp_f32 v167, v167
  v_rcp_f32 v168, v168
  v_mfma_f32_32x32x16_bf16 v[36:51], v[112:115], a[60:63], v[36:51]
  ds_read_b128 v[104:107], v2 offset:23552
  s_waitcnt lgkmcnt(4)
  v_rcp_f32 v169, v169
  v_rcp_f32 v170, v170
  v_mfma_f32_32x32x16_bf16 v[36:51], v[116:119], a[64:67], v[36:51]
  ds_read_b128 v[108:111], v2 offset:24576
  v_rcp_f32 v171, v171
  v_mul_f32 v56, v56, v164
  v_mul_f32 v57, v57, v165
  v_mul_f32 v58, v58, v166
  v_mfma_f32_32x32x16_bf16 v[36:51], v[120:123], a[68:71], v[36:51]
  ds_read_b128 v[112:115], v2 offset:25600
  v_mul_f32 v59, v59, v167
  v_mul_f32 v64, v64, v168
  v_mul_f32 v65, v65, v169
  v_mul_f32 v66, v66, v170
  v_mul_f32 v67, v67, v171
  v_mfma_f32_32x32x16_bf16 v[36:51], v[84:87], a[72:75], v[36:51]
  ds_read_b128 v[116:119], v2 offset:26624
  v_cvt_pk_bf16_f32 v172, v56, v57
  v_cvt_pk_bf16_f32 v173, v58, v59
  v_cvt_pk_bf16_f32 v174, v64, v65
  v_cvt_pk_bf16_f32 v175, v66, v67
  v_mfma_f32_32x32x16_bf16 v[36:51], v[88:91], a[76:79], v[36:51]
  ds_read_b128 v[120:123], v2 offset:27648
  s_waitcnt lgkmcnt(4)
  s_add_u32 s68, s67, 1024
  buffer_store_dwordx4 v[172:175], v2, s[4:7], s68 offen sc1
  v_mfma_f32_32x32x16_bf16 v[36:51], v[92:95], a[80:83], v[36:51]
  ds_read_b128 v[84:87], v2 offset:28672
  v_mul_f32 v152, v68, v14
  v_mul_f32 v153, v69, v14
  v_mul_f32 v154, v70, v14
  v_mul_f32 v155, v71, v14
  v_mul_f32 v156, v76, v14
  v_mfma_f32_32x32x16_bf16 v[36:51], v[96:99], a[84:87], v[36:51]
  ds_read_b128 v[88:91], v2 offset:29696
  v_mul_f32 v157, v77, v14
  v_mul_f32 v158, v78, v14
  v_mul_f32 v159, v79, v14
  v_exp_f32 v152, v152
  v_mfma_f32_32x32x16_bf16 v[36:51], v[100:103], a[88:91], v[36:51]
  ds_read_b128 v[92:95], v2 offset:30720
  v_exp_f32 v153, v153
  v_mul_f32 v72, v68, v72
  v_mul_f32 v73, v69, v73
  v_exp_f32 v154, v154
  v_mfma_f32_32x32x16_bf16 v[36:51], v[104:107], a[92:95], v[36:51]
  ds_read_b128 v[96:99], v2 offset:31744
  s_waitcnt lgkmcnt(4)
  v_exp_f32 v155, v155
  v_mul_f32 v74, v70, v74
  v_mul_f32 v75, v71, v75
  v_mfma_f32_32x32x16_bf16 v[36:51], v[108:111], a[96:99], v[36:51]
  ds_read_b128 v[100:103], v2 offset:32768
  v_exp_f32 v156, v156
  v_exp_f32 v157, v157
  v_mul_f32 v80, v76, v80
  v_mfma_f32_32x32x16_bf16 v[36:51], v[112:115], a[100:103], v[36:51]
  ds_read_b128 v[104:107], v2 offset:33792
  v_mul_f32 v81, v77, v81
  v_exp_f32 v158, v158
  v_exp_f32 v159, v159
  v_mul_f32 v82, v78, v82
  v_mfma_f32_32x32x16_bf16 v[36:51], v[116:119], a[104:107], v[36:51]
  ds_read_b128 v[108:111], v2 offset:34816
  v_mul_f32 v83, v79, v83
  v_fma_f32 v152, v152, v24, v24
  v_fma_f32 v153, v153, v24, v24
  v_fma_f32 v154, v154, v24, v24
  v_fma_f32 v155, v155, v24, v24
  v_mfma_f32_32x32x16_bf16 v[36:51], v[120:123], a[108:111], v[36:51]
  ds_read_b128 v[112:115], v2 offset:35840
  s_waitcnt lgkmcnt(4)
  v_fma_f32 v156, v156, v24, v24
  v_fma_f32 v157, v157, v24, v24
  v_fma_f32 v158, v158, v24, v24
  v_fma_f32 v159, v159, v24, v24
  v_mfma_f32_32x32x16_bf16 v[36:51], v[84:87], a[112:115], v[36:51]
  ds_read_b128 v[116:119], v2 offset:36864
  v_rcp_f32 v152, v152
  v_rcp_f32 v153, v153
  v_rcp_f32 v154, v154
  v_mfma_f32_32x32x16_bf16 v[36:51], v[88:91], a[116:119], v[36:51]
  ds_read_b128 v[120:123], v2 offset:37888
  v_rcp_f32 v155, v155
  v_rcp_f32 v156, v156
  v_mfma_f32_32x32x16_bf16 v[36:51], v[92:95], a[120:123], v[36:51]
  ds_read_b128 v[84:87], v2 offset:38912
  v_rcp_f32 v157, v157
  v_rcp_f32 v158, v158
  v_rcp_f32 v159, v159
  v_mfma_f32_32x32x16_bf16 v[36:51], v[96:99], a[124:127], v[36:51]
  ds_read_b128 v[88:91], v2 offset:39936
  v_mul_f32 v72, v72, v152
  v_mul_f32 v73, v73, v153
  v_mul_f32 v74, v74, v154
  v_mul_f32 v75, v75, v155
  v_mul_f32 v80, v80, v156
  v_mfma_f32_32x32x16_bf16 v[36:51], v[136:139], v[16:19], v[36:51]
  v_mul_f32 v81, v81, v157
  v_mul_f32 v82, v82, v158
  v_mul_f32 v83, v83, v159
  v_cvt_pk_bf16_f32 v160, v72, v73
  v_cvt_pk_bf16_f32 v161, v74, v75
  v_cvt_pk_bf16_f32 v162, v80, v81
  s_waitcnt lgkmcnt(4)
  v_mfma_f32_32x32x16_bf16 v[52:67], v[100:103], a[0:3], 0
  ds_read_b128 v[92:95], v2 offset:40960
  v_mfma_f32_32x32x16_bf16 v[52:67], v[104:107], a[4:7], v[52:67]
  ds_read_b128 v[96:99], v2 offset:41984
  v_cvt_pk_bf16_f32 v163, v82, v83
  s_add_u32 s68, s67, 2048
  buffer_store_dwordx4 v[160:163], v2, s[4:7], s68 offen sc1
  v_mfma_f32_32x32x16_bf16 v[52:67], v[108:111], a[8:11], v[52:67]
  ds_read_b128 v[100:103], v2 offset:43008
  v_mul_f32 v164, v36, v14
  s_add_u32 s22, s34, 12288
  v_mul_f32 v165, v37, v14
  v_mfma_f32_32x32x16_bf16 v[52:67], v[112:115], a[12:15], v[52:67]
  ds_read_b128 v[104:107], v2 offset:44032
  s_waitcnt lgkmcnt(4)
  buffer_load_dwordx4 a[176:179], v2, s[4:7], s22 offen offset:0 sc1
  v_mfma_f32_32x32x16_bf16 v[52:67], v[116:119], a[16:19], v[52:67]
  ds_read_b128 v[108:111], v2 offset:45056
  v_mul_f32 v166, v38, v14
  buffer_load_dwordx4 a[184:187], v2, s[4:7], s22 offen offset:2048 sc1
  v_mfma_f32_32x32x16_bf16 v[52:67], v[120:123], a[20:23], v[52:67]
  ds_read_b128 v[112:115], v2 offset:46080
  v_mul_f32 v167, v39, v14
  s_add_u32 s22, s35, 12288
  v_mul_f32 v168, v44, v14
  v_mfma_f32_32x32x16_bf16 v[52:67], v[84:87], a[24:27], v[52:67]
  ds_read_b128 v[116:119], v2 offset:47104
  buffer_load_dwordx4 a[180:183], v2, s[4:7], s22 offen offset:0 sc1
  v_mul_f32 v169, v45, v14
  v_mfma_f32_32x32x16_bf16 v[52:67], v[88:91], a[28:31], v[52:67]
  ds_read_b128 v[120:123], v2 offset:48128
  s_waitcnt lgkmcnt(4)
  buffer_load_dwordx4 a[188:191], v2, s[4:7], s22 offen offset:2048 sc1
  v_mfma_f32_32x32x16_bf16 v[52:67], v[92:95], a[32:35], v[52:67]
  ds_read_b128 v[84:87], v2 offset:49152
  v_mul_f32 v170, v46, v14
  s_add_u32 s22, s34, 16384
  v_mul_f32 v171, v47, v14
  v_mfma_f32_32x32x16_bf16 v[52:67], v[96:99], a[36:39], v[52:67]
  ds_read_b128 v[88:91], v2 offset:50176
  buffer_load_dwordx4 a[192:195], v2, s[4:7], s22 offen offset:0 sc1
  v_exp_f32 v164, v164
  v_mfma_f32_32x32x16_bf16 v[52:67], v[100:103], a[40:43], v[52:67]
  ds_read_b128 v[92:95], v2 offset:51200
  buffer_load_dwordx4 a[200:203], v2, s[4:7], s22 offen offset:2048 sc1
  v_exp_f32 v165, v165
  v_mfma_f32_32x32x16_bf16 v[52:67], v[104:107], a[44:47], v[52:67]
  ds_read_b128 v[96:99], v2 offset:52224
  s_waitcnt lgkmcnt(4)
  s_add_u32 s22, s35, 16384
  v_mul_f32 v40, v36, v40
  v_mfma_f32_32x32x16_bf16 v[52:67], v[108:111], a[48:51], v[52:67]
  ds_read_b128 v[100:103], v2 offset:53248
  buffer_load_dwordx4 a[196:199], v2, s[4:7], s22 offen offset:0 sc1
  v_mul_f32 v41, v37, v41
  v_mfma_f32_32x32x16_bf16 v[52:67], v[112:115], a[52:55], v[52:67]
  ds_read_b128 v[104:107], v2 offset:54272
  buffer_load_dwordx4 a[204:207], v2, s[4:7], s22 offen offset:2048 sc1
  v_exp_f32 v166, v166
  v_mfma_f32_32x32x16_bf16 v[52:67], v[116:119], a[56:59], v[52:67]
  ds_read_b128 v[108:111], v2 offset:55296
  s_add_u32 s22, s34, 20480
  v_exp_f32 v167, v167
  v_mfma_f32_32x32x16_bf16 v[52:67], v[120:123], a[60:63], v[52:67]
  ds_read_b128 v[112:115], v2 offset:56320
  s_waitcnt lgkmcnt(4)
  buffer_load_dwordx4 a[208:211], v2, s[4:7], s22 offen offset:0 sc1
  v_mfma_f32_32x32x16_bf16 v[52:67], v[84:87], a[64:67], v[52:67]
  ds_read_b128 v[116:119], v2 offset:57344
  v_mul_f32 v42, v38, v42
  buffer_load_dwordx4 a[216:219], v2, s[4:7], s22 offen offset:2048 sc1
  v_mfma_f32_32x32x16_bf16 v[52:67], v[88:91], a[68:71], v[52:67]
  ds_read_b128 v[120:123], v2 offset:58368
  v_mul_f32 v43, v39, v43
  s_add_u32 s22, s35, 20480
  v_exp_f32 v168, v168
  v_mfma_f32_32x32x16_bf16 v[52:67], v[92:95], a[72:75], v[52:67]
  ds_read_b128 v[84:87], v2 offset:59392
  buffer_load_dwordx4 a[212:215], v2, s[4:7], s22 offen offset:0 sc1
  v_exp_f32 v169, v169
  v_mfma_f32_32x32x16_bf16 v[52:67], v[96:99], a[76:79], v[52:67]
  ds_read_b128 v[88:91], v2 offset:60416
  s_waitcnt lgkmcnt(4)
  buffer_load_dwordx4 a[220:223], v2, s[4:7], s22 offen offset:2048 sc1
  v_mfma_f32_32x32x16_bf16 v[52:67], v[100:103], a[80:83], v[52:67]
  ds_read_b128 v[92:95], v2 offset:61440
  v_mul_f32 v48, v44, v48
  v_mul_f32 v49, v45, v49
  v_exp_f32 v170, v170
  v_mfma_f32_32x32x16_bf16 v[52:67], v[104:107], a[84:87], v[52:67]
  ds_read_b128 v[96:99], v2 offset:62464
  v_exp_f32 v171, v171
  v_mul_f32 v50, v46, v50
  v_mfma_f32_32x32x16_bf16 v[52:67], v[108:111], a[88:91], v[52:67]
  ds_read_b128 v[100:103], v2 offset:63488
  v_mul_f32 v51, v47, v51
  v_fma_f32 v164, v164, v24, v24
  v_fma_f32 v165, v165, v24, v24
  v_fma_f32 v166, v166, v24, v24
  v_mfma_f32_32x32x16_bf16 v[52:67], v[112:115], a[92:95], v[52:67]
  ds_read_b128 v[104:107], v2 offset:64512
  s_waitcnt lgkmcnt(4)
  v_fma_f32 v167, v167, v24, v24
  v_fma_f32 v168, v168, v24, v24
  v_fma_f32 v169, v169, v24, v24
  v_fma_f32 v170, v170, v24, v24
  v_mfma_f32_32x32x16_bf16 v[52:67], v[116:119], a[96:99], v[52:67]
  s_waitcnt vmcnt(35)
  s_barrier
  ds_read_b128 v[108:111], v3 offset:0
  v_fma_f32 v171, v171, v24, v24
  v_rcp_f32 v164, v164
  v_mfma_f32_32x32x16_bf16 v[52:67], v[120:123], a[100:103], v[52:67]
  ds_read_b128 v[112:115], v3 offset:1024
  v_rcp_f32 v165, v165
  v_rcp_f32 v166, v166
  v_mfma_f32_32x32x16_bf16 v[52:67], v[84:87], a[104:107], v[52:67]
  ds_read_b128 v[116:119], v3 offset:2048
  v_rcp_f32 v167, v167
  v_rcp_f32 v168, v168
  v_rcp_f32 v169, v169
  v_mfma_f32_32x32x16_bf16 v[52:67], v[88:91], a[108:111], v[52:67]
  ds_read_b128 v[120:123], v3 offset:3072
  s_waitcnt lgkmcnt(4)
  v_rcp_f32 v170, v170
  v_mfma_f32_32x32x16_bf16 v[52:67], v[92:95], a[112:115], v[52:67]
  ds_read_b128 v[84:87], v3 offset:4096
  v_rcp_f32 v171, v171
  v_mul_f32 v40, v40, v164
  v_mul_f32 v41, v41, v165
  v_mfma_f32_32x32x16_bf16 v[52:67], v[96:99], a[116:119], v[52:67]
  ds_read_b128 v[88:91], v3 offset:5120
  v_mul_f32 v42, v42, v166
  v_mul_f32 v43, v43, v167
  v_mul_f32 v48, v48, v168
  v_mul_f32 v49, v49, v169
  v_mfma_f32_32x32x16_bf16 v[52:67], v[100:103], a[120:123], v[52:67]
  ds_read_b128 v[92:95], v3 offset:6144
  v_mul_f32 v50, v50, v170
  v_mul_f32 v51, v51, v171
  v_cvt_pk_bf16_f32 v172, v40, v41
  v_cvt_pk_bf16_f32 v173, v42, v43
  v_mfma_f32_32x32x16_bf16 v[52:67], v[104:107], a[124:127], v[52:67]
  ds_read_b128 v[96:99], v3 offset:7168
  v_cvt_pk_bf16_f32 v174, v48, v49
  v_cvt_pk_bf16_f32 v175, v50, v51
  s_add_u32 s68, s67, 3072
  v_mfma_f32_32x32x16_bf16 v[52:67], v[140:143], v[16:19], v[52:67]
  buffer_store_dwordx4 v[172:175], v2, s[4:7], s68 offen sc1
  s_waitcnt lgkmcnt(4)
  v_mfma_f32_32x32x16_bf16 v[68:83], v[108:111], a[0:3], 0
  ds_read_b128 v[100:103], v3 offset:8192
  v_mfma_f32_32x32x16_bf16 v[68:83], v[112:115], a[4:7], v[68:83]
  ds_read_b128 v[104:107], v3 offset:9216
  s_nop 5
  v_mul_f32 v152, v52, v14
  s_add_u32 s22, s34, 24576
  v_mul_f32 v153, v53, v14
  v_mfma_f32_32x32x16_bf16 v[68:83], v[116:119], a[8:11], v[68:83]
  ds_read_b128 v[108:111], v3 offset:10240
  buffer_load_dwordx4 a[224:227], v2, s[4:7], s22 offen offset:0 sc1
  v_mul_f32 v154, v54, v14
  v_mfma_f32_32x32x16_bf16 v[68:83], v[120:123], a[12:15], v[68:83]
  ds_read_b128 v[112:115], v3 offset:11264
  s_waitcnt lgkmcnt(4)
  buffer_load_dwordx4 a[232:235], v2, s[4:7], s22 offen offset:2048 sc1
  v_mul_f32 v155, v55, v14
  v_mfma_f32_32x32x16_bf16 v[68:83], v[84:87], a[16:19], v[68:83]
  ds_read_b128 v[116:119], v3 offset:12288
  s_add_u32 s22, s35, 24576
  v_mul_f32 v156, v60, v14
  buffer_load_dwordx4 a[228:231], v2, s[4:7], s22 offen offset:0 sc1
  v_mfma_f32_32x32x16_bf16 v[68:83], v[88:91], a[20:23], v[68:83]
  ds_read_b128 v[120:123], v3 offset:13312
  v_mul_f32 v157, v61, v14
  buffer_load_dwordx4 a[236:239], v2, s[4:7], s22 offen offset:2048 sc1
  v_mfma_f32_32x32x16_bf16 v[68:83], v[92:95], a[24:27], v[68:83]
  ds_read_b128 v[84:87], v3 offset:14336
  v_mul_f32 v158, v62, v14
  s_add_u32 s22, s34, 28672
  v_mul_f32 v159, v63, v14
  v_mfma_f32_32x32x16_bf16 v[68:83], v[96:99], a[28:31], v[68:83]
  ds_read_b128 v[88:91], v3 offset:15360
  s_waitcnt lgkmcnt(4)
  buffer_load_dwordx4 a[240:243], v2, s[4:7], s22 offen offset:0 sc1
  v_mfma_f32_32x32x16_bf16 v[68:83], v[100:103], a[32:35], v[68:83]
  ds_read_b128 v[92:95], v3 offset:16384
  v_exp_f32 v152, v152
  buffer_load_dwordx4 a[248:251], v2, s[4:7], s22 offen offset:2048 sc1
  v_mfma_f32_32x32x16_bf16 v[68:83], v[104:107], a[36:39], v[68:83]
  ds_read_b128 v[96:99], v3 offset:17408
  v_exp_f32 v153, v153
  s_add_u32 s22, s35, 28672
  v_mfma_f32_32x32x16_bf16 v[68:83], v[108:111], a[40:43], v[68:83]
  ds_read_b128 v[100:103], v3 offset:18432
  v_mul_f32 v56, v52, v56
  buffer_load_dwordx4 a[244:247], v2, s[4:7], s22 offen offset:0 sc1
  v_mfma_f32_32x32x16_bf16 v[68:83], v[112:115], a[44:47], v[68:83]
  ds_read_b128 v[104:107], v3 offset:19456
  s_waitcnt lgkmcnt(4)
  v_mul_f32 v57, v53, v57
  buffer_load_dwordx4 a[252:255], v2, s[4:7], s22 offen offset:2048 sc1
  v_mfma_f32_32x32x16_bf16 v[68:83], v[116:119], a[48:51], v[68:83]
  ds_read_b128 v[108:111], v3 offset:20480
  v_exp_f32 v154, v154
  s_add_u32 s22, s34, 32768
  v_mfma_f32_32x32x16_bf16 v[68:83], v[120:123], a[52:55], v[68:83]
  ds_read_b128 v[112:115], v3 offset:21504
  v_exp_f32 v155, v155
  buffer_load_dwordx4 v[176:179], v2, s[4:7], s22 offen offset:0 sc1
  v_mfma_f32_32x32x16_bf16 v[68:83], v[84:87], a[56:59], v[68:83]
  ds_read_b128 v[116:119], v3 offset:22528
  v_mul_f32 v58, v54, v58
  buffer_load_dwordx4 v[184:187], v2, s[4:7], s22 offen offset:2048 sc1
  v_mfma_f32_32x32x16_bf16 v[68:83], v[88:91], a[60:63], v[68:83]
  ds_read_b128 v[120:123], v3 offset:23552
  s_waitcnt lgkmcnt(4)
  v_mul_f32 v59, v55, v59
  s_add_u32 s22, s35, 32768
  v_mfma_f32_32x32x16_bf16 v[68:83], v[92:95], a[64:67], v[68:83]
  ds_read_b128 v[84:87], v3 offset:24576
  v_exp_f32 v156, v156
  buffer_load_dwordx4 v[180:183], v2, s[4:7], s22 offen offset:0 sc1
  v_mfma_f32_32x32x16_bf16 v[68:83], v[96:99], a[68:71], v[68:83]
  ds_read_b128 v[88:91], v3 offset:25600
  v_exp_f32 v157, v157
  buffer_load_dwordx4 v[188:191], v2, s[4:7], s22 offen offset:2048 sc1
  v_mfma_f32_32x32x16_bf16 v[68:83], v[100:103], a[72:75], v[68:83]
  ds_read_b128 v[92:95], v3 offset:26624
  v_mul_f32 v64, v60, v64
  s_add_u32 s22, s34, 36864
  v_mul_f32 v65, v61, v65
  v_mfma_f32_32x32x16_bf16 v[68:83], v[104:107], a[76:79], v[68:83]
  ds_read_b128 v[96:99], v3 offset:27648
  s_waitcnt lgkmcnt(4)
  buffer_load_dwordx4 v[192:195], v2, s[4:7], s22 offen offset:0 sc1
  v_mfma_f32_32x32x16_bf16 v[68:83], v[108:111], a[80:83], v[68:83]
  ds_read_b128 v[100:103], v3 offset:28672
  v_exp_f32 v158, v158
  buffer_load_dwordx4 v[200:203], v2, s[4:7], s22 offen offset:2048 sc1
  v_mfma_f32_32x32x16_bf16 v[68:83], v[112:115], a[84:87], v[68:83]
  ds_read_b128 v[104:107], v3 offset:29696
  v_exp_f32 v159, v159
  v_mul_f32 v66, v62, v66
  v_mfma_f32_32x32x16_bf16 v[68:83], v[116:119], a[88:91], v[68:83]
  ds_read_b128 v[108:111], v3 offset:30720
  v_mul_f32 v67, v63, v67
  v_fma_f32 v152, v152, v24, v24
  v_fma_f32 v153, v153, v24, v24
  v_fma_f32 v154, v154, v24, v24
  v_mfma_f32_32x32x16_bf16 v[68:83], v[120:123], a[92:95], v[68:83]
  ds_read_b128 v[112:115], v3 offset:31744
  s_waitcnt lgkmcnt(4)
  v_fma_f32 v155, v155, v24, v24
  v_fma_f32 v156, v156, v24, v24
  v_fma_f32 v157, v157, v24, v24
  v_mfma_f32_32x32x16_bf16 v[68:83], v[84:87], a[96:99], v[68:83]
  s_waitcnt vmcnt(35)
  s_barrier
  ds_read_b128 v[116:119], v3 offset:32768
  v_fma_f32 v158, v158, v24, v24
  v_fma_f32 v159, v159, v24, v24
  v_rcp_f32 v152, v152
  v_mfma_f32_32x32x16_bf16 v[68:83], v[88:91], a[100:103], v[68:83]
  ds_read_b128 v[120:123], v3 offset:33792
  v_rcp_f32 v153, v153
  v_rcp_f32 v154, v154
  v_mfma_f32_32x32x16_bf16 v[68:83], v[92:95], a[104:107], v[68:83]
  ds_read_b128 v[84:87], v3 offset:34816
  v_rcp_f32 v155, v155
  v_rcp_f32 v156, v156
  v_mfma_f32_32x32x16_bf16 v[68:83], v[96:99], a[108:111], v[68:83]
  ds_read_b128 v[88:91], v3 offset:35840
  s_waitcnt lgkmcnt(4)
  v_rcp_f32 v157, v157
  v_rcp_f32 v158, v158
  v_mfma_f32_32x32x16_bf16 v[68:83], v[100:103], a[112:115], v[68:83]
  ds_read_b128 v[92:95], v3 offset:36864
  v_rcp_f32 v159, v159
  v_mul_f32 v56, v56, v152
  v_mul_f32 v57, v57, v153
  v_mfma_f32_32x32x16_bf16 v[68:83], v[104:107], a[116:119], v[68:83]
  ds_read_b128 v[96:99], v3 offset:37888
  v_mul_f32 v58, v58, v154
  v_mul_f32 v59, v59, v155
  v_mul_f32 v64, v64, v156
  v_mul_f32 v65, v65, v157
  v_mfma_f32_32x32x16_bf16 v[68:83], v[108:111], a[120:123], v[68:83]
  ds_read_b128 v[100:103], v3 offset:38912
  v_mul_f32 v66, v66, v158
  v_mul_f32 v67, v67, v159
  v_cvt_pk_bf16_f32 v160, v56, v57
  v_cvt_pk_bf16_f32 v161, v58, v59
  v_mfma_f32_32x32x16_bf16 v[68:83], v[112:115], a[124:127], v[68:83]
  ds_read_b128 v[104:107], v3 offset:39936
  v_cvt_pk_bf16_f32 v162, v64, v65
  v_cvt_pk_bf16_f32 v163, v66, v67
  s_add_u32 s68, s67, 4096
  v_mfma_f32_32x32x16_bf16 v[68:83], v[144:147], v[16:19], v[68:83]
  buffer_store_dwordx4 v[160:163], v2, s[4:7], s68 offen sc1
  s_waitcnt lgkmcnt(4)
  v_mfma_f32_32x32x16_bf16 v[36:51], v[116:119], a[0:3], 0
  ds_read_b128 v[108:111], v3 offset:40960
  v_mfma_f32_32x32x16_bf16 v[36:51], v[120:123], a[4:7], v[36:51]
  ds_read_b128 v[112:115], v3 offset:41984
  s_nop 5
  v_mul_f32 v164, v68, v14
  s_add_u32 s22, s35, 36864
  v_mul_f32 v165, v69, v14
  v_mfma_f32_32x32x16_bf16 v[36:51], v[84:87], a[8:11], v[36:51]
  ds_read_b128 v[116:119], v3 offset:43008
  buffer_load_dwordx4 v[196:199], v2, s[4:7], s22 offen offset:0 sc1
  v_mul_f32 v166, v70, v14
  v_mfma_f32_32x32x16_bf16 v[36:51], v[88:91], a[12:15], v[36:51]
  ds_read_b128 v[120:123], v3 offset:44032
  s_waitcnt lgkmcnt(4)
  buffer_load_dwordx4 v[204:207], v2, s[4:7], s22 offen offset:2048 sc1
  v_mfma_f32_32x32x16_bf16 v[36:51], v[92:95], a[16:19], v[36:51]
  ds_read_b128 v[84:87], v3 offset:45056
  v_mul_f32 v167, v71, v14
  s_add_u32 s22, s34, 40960
  v_mul_f32 v168, v76, v14
  v_mfma_f32_32x32x16_bf16 v[36:51], v[96:99], a[20:23], v[36:51]
  ds_read_b128 v[88:91], v3 offset:46080
  buffer_load_dwordx4 v[208:211], v2, s[4:7], s22 offen offset:0 sc1
  v_mul_f32 v169, v77, v14
  v_mfma_f32_32x32x16_bf16 v[36:51], v[100:103], a[24:27], v[36:51]
  ds_read_b128 v[92:95], v3 offset:47104
  buffer_load_dwordx4 v[216:219], v2, s[4:7], s22 offen offset:2048 sc1
  v_mul_f32 v170, v78, v14
  v_mfma_f32_32x32x16_bf16 v[36:51], v[104:107], a[28:31], v[36:51]
  ds_read_b128 v[96:99], v3 offset:48128
  s_waitcnt lgkmcnt(4)
  s_add_u32 s22, s35, 40960
  v_mul_f32 v171, v79, v14
  v_mfma_f32_32x32x16_bf16 v[36:51], v[108:111], a[32:35], v[36:51]
  ds_read_b128 v[100:103], v3 offset:49152
  buffer_load_dwordx4 v[212:215], v2, s[4:7], s22 offen offset:0 sc1
  v_exp_f32 v164, v164
  v_mfma_f32_32x32x16_bf16 v[36:51], v[112:115], a[36:39], v[36:51]
  ds_read_b128 v[104:107], v3 offset:50176
  buffer_load_dwordx4 v[220:223], v2, s[4:7], s22 offen offset:2048 sc1
  v_mfma_f32_32x32x16_bf16 v[36:51], v[116:119], a[40:43], v[36:51]
  s_waitcnt vmcnt(6)
  s_barrier
  s_cmp_lg_u32 s12, 0
  s_nop 8
  s_cbranch_scc1 Lw_49
  s_lshl_b32 s39, s13, 3
  s_add_u32 s39, s39, 6
  s_lshl_b32 s38, s2, 7
  v_mov_b32 v28, s38
  v_mov_b32 v29, s39
  s_mov_b64 exec, 1
  buffer_store_dword v29, v28, s[4:7], 0 offen offset:0 sc1
  s_mov_b64 exec, -1
Lw_49:
  ds_read_b128 v[108:111], v3 offset:51200
  v_exp_f32 v165, v165
  s_add_u32 s22, s34, 45056
  v_mul_f32 v72, v68, v72
  v_mfma_f32_32x32x16_bf16 v[36:51], v[120:123], a[44:47], v[36:51]
  ds_read_b128 v[112:115], v3 offset:52224
  s_waitcnt lgkmcnt(4)
  buffer_load_dwordx4 v[224:227], v2, s[4:7], s22 offen offset:0 sc1
  v_mfma_f32_32x32x16_bf16 v[36:51], v[84:87], a[48:51], v[36:51]
  ds_read_b128 v[116:119], v3 offset:53248
  v_mul_f32 v73, v69, v73
  buffer_load_dwordx4 v[232:235], v2, s[4:7], s22 offen offset:2048 sc1
  v_mfma_f32_32x32x16_bf16 v[36:51], v[88:91], a[52:55], v[36:51]
  ds_read_b128 v[120:123], v3 offset:54272
  v_exp_f32 v166, v166
  s_add_u32 s22, s35, 45056
  v_mfma_f32_32x32x16_bf16 v[36:51], v[92:95], a[56:59], v[36:51]
  ds_read_b128 v[84:87], v3 offset:55296
  v_exp_f32 v167, v167
  buffer_load_dwordx4 v[228:231], v2, s[4:7], s22 offen offset:0 sc1
  v_mfma_f32_32x32x16_bf16 v[36:51], v[96:99], a[60:63], v[36:51]
  ds_read_b128 v[88:91], v3 offset:56320
  s_waitcnt lgkmcnt(4)
  v_mul_f32 v74, v70, v74
  v_mfma_f32_32x32x16_bf16 v[36:51], v[100:103], a[64:67], v[36:51]
  ds_read_b128 v[92:95], v3 offset:57344
  buffer_load_dwordx4 v[236:239], v2, s[4:7], s22 offen offset:2048 sc1
  v_mul_f32 v75, v71, v75
  s_add_u32 s22, s34, 49152
  v_mfma_f32_32x32x16_bf16 v[36:51], v[104:107], a[68:71], v[36:51]
  ds_read_b128 v[96:99], v3 offset:58368
  v_exp_f32 v168, v168
  buffer_load_dwordx4 v[240:243], v2, s[4:7], s22 offen offset:0 sc1
  v_mfma_f32_32x32x16_bf16 v[36:51], v[108:111], a[72:75], v[36:51]
  ds_read_b128 v[100:103], v3 offset:59392
  v_exp_f32 v169, v169
  v_mfma_f32_32x32x16_bf16 v[36:51], v[112:115], a[76:79], v[36:51]
  ds_read_b128 v[104:107], v3 offset:60416
  s_waitcnt lgkmcnt(4)
  buffer_load_dwordx4 v[248:251], v2, s[4:7], s22 offen offset:2048 sc1
  v_mul_f32 v80, v76, v80
  v_mfma_f32_32x32x16_bf16 v[36:51], v[116:119], a[80:83], v[36:51]
  ds_read_b128 v[108:111], v3 offset:61440
  s_add_u32 s22, s35, 49152
  v_mul_f32 v81, v77, v81
  v_mfma_f32_32x32x16_bf16 v[36:51], v[120:123], a[84:87], v[36:51]
  ds_read_b128 v[112:115], v3 offset:62464
  buffer_load_dwordx4 v[244:247], v2, s[4:7], s22 offen offset:0 sc1
  v_exp_f32 v170, v170
  v_mfma_f32_32x32x16_bf16 v[36:51], v[84:87], a[88:91], v[36:51]
  ds_read_b128 v[116:119], v3 offset:63488
  buffer_load_dwordx4 v[252:255], v2, s[4:7], s22 offen offset:2048 sc1
  v_mfma_f32_32x32x16_bf16 v[36:51], v[88:91], a[92:95], v[36:51]
  ds_read_b128 v[120:123], v3 offset:64512
  v_exp_f32 v171, v171
  v_mul_f32 v82, v78, v82
  v_mul_f32 v83, v79, v83
  v_fma_f32 v164, v164, v24, v24
  s_waitcnt lgkmcnt(7)
  v_mfma_f32_32x32x16_bf16 v[36:51], v[92:95], a[96:99], v[36:51]
  v_fma_f32 v165, v165, v24, v24
  v_fma_f32 v166, v166, v24, v24
  v_fma_f32 v167, v167, v24, v24
  v_fma_f32 v168, v168, v24, v24
  s_waitcnt lgkmcnt(6)
  v_mfma_f32_32x32x16_bf16 v[36:51], v[96:99], a[100:103], v[36:51]
  v_fma_f32 v169, v169, v24, v24
  v_fma_f32 v170, v170, v24, v24
  v_fma_f32 v171, v171, v24, v24
  v_rcp_f32 v164, v164
  s_waitcnt lgkmcnt(5)
  v_mfma_f32_32x32x16_bf16 v[36:51], v[100:103], a[104:107], v[36:51]
  v_rcp_f32 v165, v165
  v_rcp_f32 v166, v166
  v_rcp_f32 v167, v167
  s_waitcnt lgkmcnt(4)
  v_mfma_f32_32x32x16_bf16 v[36:51], v[104:107], a[108:111], v[36:51]
  v_rcp_f32 v168, v168
  v_rcp_f32 v169, v169
  s_waitcnt lgkmcnt(3)
  v_mfma_f32_32x32x16_bf16 v[36:51], v[108:111], a[112:115], v[36:51]
  v_rcp_f32 v170, v170
  v_rcp_f32 v171, v171
  v_mul_f32 v72, v72, v164
  s_waitcnt lgkmcnt(2)
  v_mfma_f32_32x32x16_bf16 v[36:51], v[112:115], a[116:119], v[36:51]
  v_mul_f32 v73, v73, v165
  v_mul_f32 v74, v74, v166
  v_mul_f32 v75, v75, v167
  v_mul_f32 v80, v80, v168
  v_mul_f32 v81, v81, v169
  s_waitcnt lgkmcnt(1)
  v_mfma_f32_32x32x16_bf16 v[36:51], v[116:119], a[120:123], v[36:51]
  v_mul_f32 v82, v82, v170
  v_mul_f32 v83, v83, v171
  v_cvt_pk_bf16_f32 v172, v72, v73
  v_cvt_pk_bf16_f32 v173, v74, v75
  s_waitcnt lgkmcnt(0)
  v_mfma_f32_32x32x16_bf16 v[36:51], v[120:123], a[124:127], v[36:51]
  v_cvt_pk_bf16_f32 v174, v80, v81
  v_cvt_pk_bf16_f32 v175, v82, v83
  s_add_u32 s68, s67, 5120
  v_mfma_f32_32x32x16_bf16 v[36:51], v[148:151], v[16:19], v[36:51]
  buffer_store_dwordx4 v[172:175], v2, s[4:7], s68 offen sc1
  s_nop 10
  v_pk_mul_f32 v[152:153], v[36:37], v[14:15] op_sel_hi:[1,0]
  v_pk_mul_f32 v[154:155], v[38:39], v[14:15] op_sel_hi:[1,0]
  v_pk_mul_f32 v[156:157], v[44:45], v[14:15] op_sel_hi:[1,0]
  v_pk_mul_f32 v[158:159], v[46:47], v[14:15] op_sel_hi:[1,0]
  v_exp_f32 v152, v152
  v_exp_f32 v153, v153
  v_pk_mul_f32 v[40:41], v[36:37], v[40:41]
  v_exp_f32 v154, v154
  v_exp_f32 v155, v155
  v_pk_mul_f32 v[42:43], v[38:39], v[42:43]
  v_exp_f32 v156, v156
  v_exp_f32 v157, v157
  v_pk_mul_f32 v[48:49], v[44:45], v[48:49]
  v_exp_f32 v158, v158
  v_exp_f32 v159, v159
  v_pk_mul_f32 v[50:51], v[46:47], v[50:51]
  v_pk_fma_f32 v[152:153], v[152:153], v[24:25], v[24:25] op_sel_hi:[1,0,0]
  v_pk_fma_f32 v[154:155], v[154:155], v[24:25], v[24:25] op_sel_hi:[1,0,0]
  v_pk_fma_f32 v[156:157], v[156:157], v[24:25], v[24:25] op_sel_hi:[1,0,0]
  v_pk_fma_f32 v[158:159], v[158:159], v[24:25], v[24:25] op_sel_hi:[1,0,0]
  v_rcp_f32 v152, v152
  v_rcp_f32 v153, v153
  v_rcp_f32 v154, v154
  v_rcp_f32 v155, v155
  v_rcp_f32 v156, v156
  v_rcp_f32 v157, v157
  v_rcp_f32 v158, v158
  v_rcp_f32 v159, v159
  v_pk_mul_f32 v[40:41], v[40:41], v[152:153]
  v_pk_mul_f32 v[42:43], v[42:43], v[154:155]
  v_pk_mul_f32 v[48:49], v[48:49], v[156:157]
  v_pk_mul_f32 v[50:51], v[50:51], v[158:159]
  v_cvt_pk_bf16_f32 v160, v40, v41
  v_cvt_pk_bf16_f32 v161, v42, v43
  v_cvt_pk_bf16_f32 v162, v48, v49
  v_cvt_pk_bf16_f32 v163, v50, v51
  s_add_u32 s68, s67, 6144
  buffer_store_dwordx4 v[160:163], v2, s[4:7], s68 offen sc1
  s_add_u32 s22, s34, 53248
  buffer_load_dwordx4 v[136:139], v2, s[4:7], s22 offen offset:0 sc1
  buffer_load_dwordx4 v[144:147], v2, s[4:7], s22 offen offset:2048 sc1
  s_add_u32 s22, s35, 53248
  buffer_load_dwordx4 v[140:143], v2, s[4:7], s22 offen offset:0 sc1
  buffer_load_dwordx4 v[148:151], v2, s[4:7], s22 offen offset:2048 sc1
  s_cmp_lg_u32 s12, 0
  s_cbranch_scc1 Lw_50
  v_and_b32 v29, 15, v1
  s_lshr_b32 s36, s16, 1
  s_and_b32 s37, s36, 7
  s_lshl_b32 s37, s37, 5
  s_lshr_b32 s36, s36, 3
  s_lshl_b32 s36, s36, 2
  s_or_b32 s36, s36, s37
  v_and_b32 v28, 3, v29
  v_lshlrev_b32 v28, 3, v28
  v_lshrrev_b32 v29, 2, v29
  v_add_u32 v28, v28, v29
  v_add_u32 v28, s36, v28
  v_lshlrev_b32 v28, 7, v28
  s_lshl_b32 s39, s13, 3
  s_add_u32 s39, s39, 6
  s_mov_b32 s38, 0
  buffer_load_dword v30, v28, s[4:7], 0 offen sc1
  buffer_load_dword v32, v28, s[4:7], 0 offen sc1
Lpoll_51:
  s_waitcnt vmcnt(1)
  v_cmp_gt_u32 vcc, s39, v30
  s_nop 4
  s_cbranch_vccz Lpolld_52
  buffer_load_dword v30, v28, s[4:7], 0 offen sc1
  s_waitcnt vmcnt(1)
  v_cmp_gt_u32 vcc, s39, v32
  s_nop 4
  s_cbranch_vccz Lpolld_52
  buffer_load_dword v32, v28, s[4:7], 0 offen sc1
  s_add_u32 s38, s38, 1
  s_cmp_le_u32 s38, 200000
  s_cbranch_scc1 Lpoll_51
Lpolld_52:
Lw_50:
  s_waitcnt vmcnt(4)
  s_barrier
  s_cmp_lg_u32 s12, 0
  s_cbranch_scc1 Lw_53
  s_lshl_b32 s39, s13, 3
  s_add_u32 s39, s39, 7
  s_lshl_b32 s38, s2, 7
  v_mov_b32 v28, s38
  v_mov_b32 v29, s39
  s_mov_b64 exec, 1
  buffer_store_dword v29, v28, s[4:7], 0 offen offset:0 sc1
  s_mov_b64 exec, -1
Lw_53:
  s_cmp_eq_u32 s13, 0
  s_mov_b32 s20, 0x2300000
  s_cselect_b32 s20, 0x1b00000, s20
  s_mul_i32 s21, s12, 28672
  s_add_u32 s20, s20, s21
  s_lshr_b32 s21, s12, 1
  s_xor_b32 s22, s21, 0
  s_lshl_b32 s23, s16, 1
  s_add_u32 s22, s22, s23
  s_mul_i32 s22, s22, 114688
  s_add_u32 s30, s20, s22
  s_xor_b32 s22, s21, 1
  s_lshl_b32 s23, s16, 1
  s_add_u32 s22, s22, s23
  s_mul_i32 s22, s22, 114688
  s_add_u32 s31, s20, s22
  s_add_u32 s22, s30, 0
  buffer_load_dwordx4 a[0:3], v2, s[4:7], s22 offen offset:0 sc1
  s_add_u32 s22, s31, 0
  buffer_load_dwordx4 a[4:7], v2, s[4:7], s22 offen offset:0 sc1
  s_add_u32 s22, s30, 4096
  buffer_load_dwordx4 a[8:11], v2, s[4:7], s22 offen offset:3072 sc1
  s_add_u32 s22, s31, 4096
  buffer_load_dwordx4 a[12:15], v2, s[4:7], s22 offen offset:3072 sc1
  s_add_u32 s22, s30, 12288
  buffer_load_dwordx4 a[16:19], v2, s[4:7], s22 offen offset:2048 sc1
  s_add_u32 s22, s31, 12288
  buffer_load_dwordx4 a[20:23], v2, s[4:7], s22 offen offset:2048 sc1
  s_add_u32 s22, s30, 20480
  buffer_load_dwordx4 a[24:27], v2, s[4:7], s22 offen offset:1024 sc1
  s_add_u32 s22, s31, 20480
  buffer_load_dwordx4 a[28:31], v2, s[4:7], s22 offen offset:1024 sc1
  s_add_u32 s22, s30, 0
  buffer_load_dwordx4 a[32:35], v2, s[4:7], s22 offen offset:1024 sc1
  s_add_u32 s22, s31, 0
  buffer_load_dwordx4 a[36:39], v2, s[4:7], s22 offen offset:1024 sc1
  s_add_u32 s22, s30, 8192
  buffer_load_dwordx4 a[40:43], v2, s[4:7], s22 offen offset:0 sc1
  s_add_u32 s22, s31, 8192
  buffer_load_dwordx4 a[44:47], v2, s[4:7], s22 offen offset:0 sc1
  s_waitcnt vmcnt(11)
  v_mfma_f32_32x32x16_bf16 v[32:47], a[128:131], a[0:3], 0
  s_waitcnt vmcnt(10)
  v_mfma_f32_32x32x16_bf16 v[64:79], a[128:131], a[4:7], 0
  v_mfma_f32_32x32x16_bf16 v[48:63], a[132:135], a[0:3], 0
  v_mfma_f32_32x32x16_bf16 v[80:95], a[132:135], a[4:7], 0
  s_add_u32 s22, s30, 12288
  buffer_load_dwordx4 a[48:51], v2, s[4:7], s22 offen offset:3072 sc1
  s_add_u32 s22, s31, 12288
  buffer_load_dwordx4 a[52:55], v2, s[4:7], s22 offen offset:3072 sc1
  v_and_b32 v153, 15, v1
  s_lshr_b32 s36, s16, 1
  s_and_b32 s37, s36, 7
  s_lshl_b32 s37, s37, 5
  s_lshr_b32 s36, s36, 3
  s_lshl_b32 s36, s36, 2
  s_or_b32 s36, s36, s37
  v_and_b32 v152, 3, v153
  v_lshlrev_b32 v152, 3, v152
  v_lshrrev_b32 v153, 2, v153
  v_add_u32 v152, v152, v153
  v_add_u32 v152, s36, v152
  v_lshlrev_b32 v152, 7, v152
  s_lshl_b32 s39, s13, 3
  s_add_u32 s39, s39, 7
  s_waitcnt vmcnt(11)
  v_mfma_f32_32x32x16_bf16 v[32:47], a[136:139], a[8:11], v[32:47]
  s_waitcnt vmcnt(10)
  v_mfma_f32_32x32x16_bf16 v[64:79], a[136:139], a[12:15], v[64:79]
  v_mfma_f32_32x32x16_bf16 v[48:63], a[140:143], a[8:11], v[48:63]
  v_mfma_f32_32x32x16_bf16 v[80:95], a[140:143], a[12:15], v[80:95]
  s_add_u32 s22, s30, 20480
  buffer_load_dwordx4 a[56:59], v2, s[4:7], s22 offen offset:2048 sc1
  s_add_u32 s22, s31, 20480
  buffer_load_dwordx4 a[60:63], v2, s[4:7], s22 offen offset:2048 sc1
  s_waitcnt vmcnt(11)
  v_mfma_f32_32x32x16_bf16 v[32:47], a[144:147], a[16:19], v[32:47]
  s_waitcnt vmcnt(10)
  v_mfma_f32_32x32x16_bf16 v[64:79], a[144:147], a[20:23], v[64:79]
  v_mfma_f32_32x32x16_bf16 v[48:63], a[148:151], a[16:19], v[48:63]
  v_mfma_f32_32x32x16_bf16 v[80:95], a[148:151], a[20:23], v[80:95]
  s_add_u32 s22, s30, 0
  buffer_load_dwordx4 a[64:67], v2, s[4:7], s22 offen offset:2048 sc1
  s_add_u32 s22, s31, 0
  buffer_load_dwordx4 a[68:71], v2, s[4:7], s22 offen offset:2048 sc1
  s_waitcnt vmcnt(11)
  v_mfma_f32_32x32x16_bf16 v[32:47], a[152:155], a[24:27], v[32:47]
  s_waitcnt vmcnt(10)
  v_mfma_f32_32x32x16_bf16 v[64:79], a[152:155], a[28:31], v[64:79]
  v_mfma_f32_32x32x16_bf16 v[48:63], a[156:159], a[24:27], v[48:63]
  v_mfma_f32_32x32x16_bf16 v[80:95], a[156:159], a[28:31], v[80:95]
  s_add_u32 s22, s30, 8192
  buffer_load_dwordx4 a[72:75], v2, s[4:7], s22 offen offset:1024 sc1
  s_add_u32 s22, s31, 8192
  buffer_load_dwordx4 a[76:79], v2, s[4:7], s22 offen offset:1024 sc1
  s_waitcnt vmcnt(11)
  v_mfma_f32_32x32x16_bf16 v[32:47], a[160:163], a[32:35], v[32:47]
  s_waitcnt vmcnt(10)
  v_mfma_f32_32x32x16_bf16 v[64:79], a[160:163], a[36:39], v[64:79]
  v_mfma_f32_32x32x16_bf16 v[48:63], a[164:167], a[32:35], v[48:63]
  v_mfma_f32_32x32x16_bf16 v[80:95], a[164:167], a[36:39], v[80:95]
  s_add_u32 s22, s30, 16384
  buffer_load_dwordx4 a[80:83], v2, s[4:7], s22 offen offset:0 sc1
  s_add_u32 s22, s31, 16384
  buffer_load_dwordx4 a[84:87], v2, s[4:7], s22 offen offset:0 sc1
  s_waitcnt vmcnt(11)
  v_mfma_f32_32x32x16_bf16 v[32:47], a[168:171], a[40:43], v[32:47]
  s_waitcnt vmcnt(10)
  v_mfma_f32_32x32x16_bf16 v[64:79], a[168:171], a[44:47], v[64:79]
  v_mfma_f32_32x32x16_bf16 v[48:63], a[172:175], a[40:43], v[48:63]
  v_mfma_f32_32x32x16_bf16 v[80:95], a[172:175], a[44:47], v[80:95]
  s_add_u32 s22, s30, 20480
  buffer_load_dwordx4 a[88:91], v2, s[4:7], s22 offen offset:3072 sc1
  s_add_u32 s22, s31, 20480
  buffer_load_dwordx4 a[92:95], v2, s[4:7], s22 offen offset:3072 sc1
  s_waitcnt vmcnt(11)
  v_mfma_f32_32x32x16_bf16 v[32:47], a[176:179], a[48:51], v[32:47]
  s_waitcnt vmcnt(10)
  v_mfma_f32_32x32x16_bf16 v[64:79], a[176:179], a[52:55], v[64:79]
  v_mfma_f32_32x32x16_bf16 v[48:63], a[180:183], a[48:51], v[48:63]
  v_mfma_f32_32x32x16_bf16 v[80:95], a[180:183], a[52:55], v[80:95]
  s_add_u32 s22, s30, 0
  buffer_load_dwordx4 a[96:99], v2, s[4:7], s22 offen offset:3072 sc1
  s_add_u32 s22, s31, 0
  buffer_load_dwordx4 a[100:103], v2, s[4:7], s22 offen offset:3072 sc1
  s_waitcnt vmcnt(11)
  v_mfma_f32_32x32x16_bf16 v[32:47], a[184:187], a[56:59], v[32:47]
  s_waitcnt vmcnt(10)
  v_mfma_f32_32x32x16_bf16 v[64:79], a[184:187], a[60:63], v[64:79]
  v_mfma_f32_32x32x16_bf16 v[48:63], a[188:191], a[56:59], v[48:63]
  v_mfma_f32_32x32x16_bf16 v[80:95], a[188:191], a[60:63], v[80:95]
  s_add_u32 s22, s30, 8192
  buffer_load_dwordx4 a[104:107], v2, s[4:7], s22 offen offset:2048 sc1
  s_add_u32 s22, s31, 8192
  buffer_load_dwordx4 a[108:111], v2, s[4:7], s22 offen offset:2048 sc1
  buffer_load_dword v153, v152, s[4:7], 0 offen sc1
  s_waitcnt vmcnt(12)
  v_mfma_f32_32x32x16_bf16 v[32:47], a[192:195], a[64:67], v[32:47]
  s_waitcnt vmcnt(11)
  v_mfma_f32_32x32x16_bf16 v[64:79], a[192:195], a[68:71], v[64:79]
  v_mfma_f32_32x32x16_bf16 v[48:63], a[196:199], a[64:67], v[48:63]
  v_mfma_f32_32x32x16_bf16 v[80:95], a[196:199], a[68:71], v[80:95]
  s_add_u32 s22, s30, 16384
  buffer_load_dwordx4 a[112:115], v2, s[4:7], s22 offen offset:1024 sc1
  s_add_u32 s22, s31, 16384
  buffer_load_dwordx4 a[116:119], v2, s[4:7], s22 offen offset:1024 sc1
  s_waitcnt vmcnt(12)
  v_mfma_f32_32x32x16_bf16 v[32:47], a[200:203], a[72:75], v[32:47]
  s_waitcnt vmcnt(11)
  v_mfma_f32_32x32x16_bf16 v[64:79], a[200:203], a[76:79], v[64:79]
  v_mfma_f32_32x32x16_bf16 v[48:63], a[204:207], a[72:75], v[48:63]
  v_mfma_f32_32x32x16_bf16 v[80:95], a[204:207], a[76:79], v[80:95]
  s_add_u32 s22, s30, 24576
  buffer_load_dwordx4 a[120:123], v2, s[4:7], s22 offen offset:0 sc1
  s_add_u32 s22, s31, 24576
  buffer_load_dwordx4 a[124:127], v2, s[4:7], s22 offen offset:0 sc1
  s_lshl_b32 s23, s16, 1
  s_lshr_b32 s24, s12, 1
  s_add_u32 s23, s23, s24
  s_lshl_b32 s24, s17, 1
  s_and_b32 s25, s12, 1
  s_add_u32 s24, s24, s25
  s_cmp_eq_u32 s13, 0
  s_mov_b32 s25, 0x1000000
  s_cselect_b32 s25, 0xc00000, s25
  s_lshl_b32 s26, s23, 15
  s_add_u32 s25, s25, s26
  s_lshl_b32 s26, s24, 11
  s_add_u32 s25, s25, s26
  buffer_load_dwordx4 v[96:99], v2, s[4:7], s25 offen sc1
  buffer_load_dwordx4 v[100:103], v2, s[4:7], s25 offen offset:1024 sc1
  s_waitcnt vmcnt(14)
  v_mfma_f32_32x32x16_bf16 v[32:47], a[208:211], a[80:83], v[32:47]
  s_waitcnt vmcnt(13)
  v_mfma_f32_32x32x16_bf16 v[64:79], a[208:211], a[84:87], v[64:79]
  v_mfma_f32_32x32x16_bf16 v[48:63], a[212:215], a[80:83], v[48:63]
  v_mfma_f32_32x32x16_bf16 v[80:95], a[212:215], a[84:87], v[80:95]
  s_mov_b32 s38, 0
  s_waitcnt vmcnt(6)
  v_cmp_gt_u32 vcc, s39, v153
  s_nop 8
  s_cbranch_vccz Lhd_55
Lhp_54:
  s_add_u32 s38, s38, 1
  s_cmp_gt_u32 s38, 200000
  s_cbranch_scc1 Lhd_55
  buffer_load_dword v153, v152, s[4:7], 0 offen sc1
  s_waitcnt vmcnt(0)
  v_cmp_gt_u32 vcc, s39, v153
  s_nop 4
  s_cbranch_vccnz Lhp_54
Lhd_55:
  v_mfma_f32_32x32x16_bf16 v[32:47], a[216:219], a[88:91], v[32:47]
  v_mfma_f32_32x32x16_bf16 v[64:79], a[216:219], a[92:95], v[64:79]
  v_mfma_f32_32x32x16_bf16 v[48:63], a[220:223], a[88:91], v[48:63]
  v_mfma_f32_32x32x16_bf16 v[80:95], a[220:223], a[92:95], v[80:95]
  s_add_u32 s22, s30, 4096
  buffer_load_dwordx4 a[0:3], v2, s[4:7], s22 offen offset:0 sc1
  s_add_u32 s22, s31, 4096
  buffer_load_dwordx4 a[4:7], v2, s[4:7], s22 offen offset:0 sc1
  s_add_u32 s22, s30, 8192
  buffer_load_dwordx4 a[8:11], v2, s[4:7], s22 offen offset:3072 sc1
  s_add_u32 s22, s31, 8192
  buffer_load_dwordx4 a[12:15], v2, s[4:7], s22 offen offset:3072 sc1
  v_mfma_f32_32x32x16_bf16 v[32:47], a[224:227], a[96:99], v[32:47]
  v_mfma_f32_32x32x16_bf16 v[64:79], a[224:227], a[100:103], v[64:79]
  v_mfma_f32_32x32x16_bf16 v[48:63], a[228:231], a[96:99], v[48:63]
  v_mfma_f32_32x32x16_bf16 v[80:95], a[228:231], a[100:103], v[80:95]
  s_add_u32 s22, s30, 16384
  buffer_load_dwordx4 a[16:19], v2, s[4:7], s22 offen offset:2048 sc1
  s_add_u32 s22, s31, 16384
  buffer_load_dwordx4 a[20:23], v2, s[4:7], s22 offen offset:2048 sc1
  v_mfma_f32_32x32x16_bf16 v[32:47], a[232:235], a[104:107], v[32:47]
  v_mfma_f32_32x32x16_bf16 v[64:79], a[232:235], a[108:111], v[64:79]
  v_mfma_f32_32x32x16_bf16 v[48:63], a[236:239], a[104:107], v[48:63]
  v_mfma_f32_32x32x16_bf16 v[80:95], a[236:239], a[108:111], v[80:95]
  s_add_u32 s22, s30, 24576
  buffer_load_dwordx4 a[24:27], v2, s[4:7], s22 offen offset:1024 sc1
  s_add_u32 s22, s31, 24576
  buffer_load_dwordx4 a[28:31], v2, s[4:7], s22 offen offset:1024 sc1
  s_waitcnt vmcnt(13)
  v_mfma_f32_32x32x16_bf16 v[32:47], a[240:243], a[112:115], v[32:47]
  s_waitcnt vmcnt(12)
  v_mfma_f32_32x32x16_bf16 v[64:79], a[240:243], a[116:119], v[64:79]
  v_mfma_f32_32x32x16_bf16 v[48:63], a[244:247], a[112:115], v[48:63]
  v_mfma_f32_32x32x16_bf16 v[80:95], a[244:247], a[116:119], v[80:95]
  s_add_u32 s22, s30, 4096
  buffer_load_dwordx4 a[32:35], v2, s[4:7], s22 offen offset:1024 sc1
  s_add_u32 s22, s31, 4096
  buffer_load_dwordx4 a[36:39], v2, s[4:7], s22 offen offset:1024 sc1
  s_waitcnt vmcnt(13)
  v_mfma_f32_32x32x16_bf16 v[32:47], a[248:251], a[120:123], v[32:47]
  s_waitcnt vmcnt(12)
  v_mfma_f32_32x32x16_bf16 v[64:79], a[248:251], a[124:127], v[64:79]
  v_mfma_f32_32x32x16_bf16 v[48:63], a[252:255], a[120:123], v[48:63]
  v_mfma_f32_32x32x16_bf16 v[80:95], a[252:255], a[124:127], v[80:95]
  s_add_u32 s22, s30, 12288
  buffer_load_dwordx4 a[40:43], v2, s[4:7], s22 offen offset:0 sc1
  s_add_u32 s22, s31, 12288
  buffer_load_dwordx4 a[44:47], v2, s[4:7], s22 offen offset:0 sc1
  s_waitcnt vmcnt(11)
  v_mfma_f32_32x32x16_bf16 v[32:47], v[176:179], a[0:3], v[32:47]
  s_waitcnt vmcnt(10)
  v_mfma_f32_32x32x16_bf16 v[64:79], v[176:179], a[4:7], v[64:79]
  v_mfma_f32_32x32x16_bf16 v[48:63], v[180:183], a[0:3], v[48:63]
  v_mfma_f32_32x32x16_bf16 v[80:95], v[180:183], a[4:7], v[80:95]
  s_add_u32 s22, s30, 16384
  buffer_load_dwordx4 a[48:51], v2, s[4:7], s22 offen offset:3072 sc1
  s_add_u32 s22, s31, 16384
  buffer_load_dwordx4 a[52:55], v2, s[4:7], s22 offen offset:3072 sc1
  s_waitcnt vmcnt(11)
  v_mfma_f32_32x32x16_bf16 v[32:47], v[184:187], a[8:11], v[32:47]
  s_waitcnt vmcnt(10)
  v_mfma_f32_32x32x16_bf16 v[64:79], v[184:187], a[12:15], v[64:79]
  v_mfma_f32_32x32x16_bf16 v[48:63], v[188:191], a[8:11], v[48:63]
  v_mfma_f32_32x32x16_bf16 v[80:95], v[188:191], a[12:15], v[80:95]
  s_add_u32 s22, s30, 24576
  buffer_load_dwordx4 a[56:59], v2, s[4:7], s22 offen offset:2048 sc1
  s_add_u32 s22, s31, 24576
  buffer_load_dwordx4 a[60:63], v2, s[4:7], s22 offen offset:2048 sc1
  s_waitcnt vmcnt(11)
  v_mfma_f32_32x32x16_bf16 v[32:47], v[192:195], a[16:19], v[32:47]
  s_waitcnt vmcnt(10)
  v_mfma_f32_32x32x16_bf16 v[64:79], v[192:195], a[20:23], v[64:79]
  v_mfma_f32_32x32x16_bf16 v[48:63], v[196:199], a[16:19], v[48:63]
  v_mfma_f32_32x32x16_bf16 v[80:95], v[196:199], a[20:23], v[80:95]
  s_add_u32 s22, s30, 4096
  buffer_load_dwordx4 a[64:67], v2, s[4:7], s22 offen offset:2048 sc1
  s_add_u32 s22, s31, 4096
  buffer_load_dwordx4 a[68:71], v2, s[4:7], s22 offen offset:2048 sc1
  s_waitcnt vmcnt(11)
  v_mfma_f32_32x32x16_bf16 v[32:47], v[200:203], a[24:27], v[32:47]
  s_waitcnt vmcnt(10)
  v_mfma_f32_32x32x16_bf16 v[64:79], v[200:203], a[28:31], v[64:79]
  v_mfma_f32_32x32x16_bf16 v[48:63], v[204:207], a[24:27], v[48:63]
  v_mfma_f32_32x32x16_bf16 v[80:95], v[204:207], a[28:31], v[80:95]
  s_add_u32 s22, s30, 12288
  buffer_load_dwordx4 a[72:75], v2, s[4:7], s22 offen offset:1024 sc1
  s_add_u32 s22, s31, 12288
  buffer_load_dwordx4 a[76:79], v2, s[4:7], s22 offen offset:1024 sc1
  s_waitcnt vmcnt(11)
  v_mfma_f32_32x32x16_bf16 v[32:47], v[208:211], a[32:35], v[32:47]
  s_waitcnt vmcnt(10)
  v_mfma_f32_32x32x16_bf16 v[64:79], v[208:211], a[36:39], v[64:79]
  v_mfma_f32_32x32x16_bf16 v[48:63], v[212:215], a[32:35], v[48:63]
  v_mfma_f32_32x32x16_bf16 v[80:95], v[212:215], a[36:39], v[80:95]
  s_add_u32 s22, s30, 20480
  buffer_load_dwordx4 a[80:83], v2, s[4:7], s22 offen offset:0 sc1
  s_add_u32 s22, s31, 20480
  buffer_load_dwordx4 a[84:87], v2, s[4:7], s22 offen offset:0 sc1
  s_waitcnt vmcnt(11)
  v_mfma_f32_32x32x16_bf16 v[32:47], v[216:219], a[40:43], v[32:47]
  s_waitcnt vmcnt(10)
  v_mfma_f32_32x32x16_bf16 v[64:79], v[216:219], a[44:47], v[64:79]
  v_mfma_f32_32x32x16_bf16 v[48:63], v[220:223], a[40:43], v[48:63]
  v_mfma_f32_32x32x16_bf16 v[80:95], v[220:223], a[44:47], v[80:95]
  s_add_u32 s22, s30, 24576
  buffer_load_dwordx4 a[88:91], v2, s[4:7], s22 offen offset:3072 sc1
  s_add_u32 s22, s31, 24576
  buffer_load_dwordx4 a[92:95], v2, s[4:7], s22 offen offset:3072 sc1
  s_waitcnt vmcnt(11)
  v_mfma_f32_32x32x16_bf16 v[32:47], v[224:227], a[48:51], v[32:47]
  s_waitcnt vmcnt(10)
  v_mfma_f32_32x32x16_bf16 v[64:79], v[224:227], a[52:55], v[64:79]
  v_mfma_f32_32x32x16_bf16 v[48:63], v[228:231], a[48:51], v[48:63]
  v_mfma_f32_32x32x16_bf16 v[80:95], v[228:231], a[52:55], v[80:95]
  s_waitcnt vmcnt(9)
  v_mfma_f32_32x32x16_bf16 v[32:47], v[232:235], a[56:59], v[32:47]
  s_waitcnt vmcnt(8)
  v_mfma_f32_32x32x16_bf16 v[64:79], v[232:235], a[60:63], v[64:79]
  v_mfma_f32_32x32x16_bf16 v[48:63], v[236:239], a[56:59], v[48:63]
  v_mfma_f32_32x32x16_bf16 v[80:95], v[236:239], a[60:63], v[80:95]
  s_waitcnt vmcnt(7)
  v_mfma_f32_32x32x16_bf16 v[32:47], v[240:243], a[64:67], v[32:47]
  s_waitcnt vmcnt(6)
  v_mfma_f32_32x32x16_bf16 v[64:79], v[240:243], a[68:71], v[64:79]
  v_mfma_f32_32x32x16_bf16 v[48:63], v[244:247], a[64:67], v[48:63]
  v_mfma_f32_32x32x16_bf16 v[80:95], v[244:247], a[68:71], v[80:95]
  s_waitcnt vmcnt(5)
  v_mfma_f32_32x32x16_bf16 v[32:47], v[248:251], a[72:75], v[32:47]
  s_waitcnt vmcnt(4)
  v_mfma_f32_32x32x16_bf16 v[64:79], v[248:251], a[76:79], v[64:79]
  v_mfma_f32_32x32x16_bf16 v[48:63], v[252:255], a[72:75], v[48:63]
  v_mfma_f32_32x32x16_bf16 v[80:95], v[252:255], a[76:79], v[80:95]
  s_waitcnt vmcnt(3)
  v_mfma_f32_32x32x16_bf16 v[32:47], v[136:139], a[80:83], v[32:47]
  s_waitcnt vmcnt(2)
  v_mfma_f32_32x32x16_bf16 v[64:79], v[136:139], a[84:87], v[64:79]
  v_mfma_f32_32x32x16_bf16 v[48:63], v[140:143], a[80:83], v[48:63]
  v_mfma_f32_32x32x16_bf16 v[80:95], v[140:143], a[84:87], v[80:95]
  s_waitcnt vmcnt(1)
  v_mfma_f32_32x32x16_bf16 v[32:47], v[144:147], a[88:91], v[32:47]
  s_waitcnt vmcnt(0)
  v_mfma_f32_32x32x16_bf16 v[64:79], v[144:147], a[92:95], v[64:79]
  v_mfma_f32_32x32x16_bf16 v[48:63], v[148:151], a[88:91], v[48:63]
  v_mfma_f32_32x32x16_bf16 v[80:95], v[148:151], a[92:95], v[80:95]
  s_mul_i32 s26, s12, 8192
  s_add_u32 s26, s26, 98304
  v_add_u32 v13, s26, v2
  s_nop 7
  ds_write_b128 v13, v[48:51] offset:32768
  ds_write_b128 v13, v[52:55] offset:33792
  ds_write_b128 v13, v[56:59] offset:34816
  ds_write_b128 v13, v[60:63] offset:35840
  ds_write_b128 v13, v[64:67] offset:36864
  ds_write_b128 v13, v[68:71] offset:37888
  ds_write_b128 v13, v[72:75] offset:38912
  ds_write_b128 v13, v[76:79] offset:39936
  ds_write_b128 v13, v[80:83] offset:0
  ds_write_b128 v13, v[84:87] offset:1024
  ds_write_b128 v13, v[88:91] offset:2048
  ds_write_b128 v13, v[92:95] offset:3072
  s_xor_b32 s27, s12, 1
  s_mul_i32 s27, s27, 8192
  s_add_u32 s27, s27, 131072
  v_add_u32 v25, s27, v2
  s_xor_b32 s27, s12, 2
  s_mul_i32 s27, s27, 8192
  s_add_u32 s27, s27, 135168
  v_add_u32 v26, s27, v2
  s_xor_b32 s27, s12, 3
  s_mul_i32 s27, s27, 8192
  s_add_u32 s27, s27, 98304
  v_add_u32 v27, s27, v2
  s_waitcnt lgkmcnt(0)
  s_barrier
  ds_read_b128 v[104:107], v25 offset:0
  ds_read_b128 v[108:111], v25 offset:1024
  ds_read_b128 v[112:115], v25 offset:2048
  ds_read_b128 v[116:119], v25 offset:3072
  ds_read_b128 v[120:123], v26 offset:0
  ds_read_b128 v[124:127], v26 offset:1024
  v_lshlrev_b32 v48, 16, v96
  v_and_b32 v49, 0xffff0000, v96
  v_lshlrev_b32 v50, 16, v97
  v_and_b32 v51, 0xffff0000, v97
  v_lshlrev_b32 v52, 16, v98
  v_and_b32 v53, 0xffff0000, v98
  v_lshlrev_b32 v54, 16, v99
  v_and_b32 v55, 0xffff0000, v99
  v_lshlrev_b32 v56, 16, v100
  v_and_b32 v57, 0xffff0000, v100
  v_lshlrev_b32 v58, 16, v101
  v_and_b32 v59, 0xffff0000, v101
  v_lshlrev_b32 v60, 16, v102
  v_and_b32 v61, 0xffff0000, v102
  v_lshlrev_b32 v62, 16, v103
  v_and_b32 v63, 0xffff0000, v103
  v_pk_add_f32 v[32:33], v[32:33], v[48:49]
  v_pk_add_f32 v[34:35], v[34:35], v[50:51]
  v_pk_add_f32 v[36:37], v[36:37], v[52:53]
  v_pk_add_f32 v[38:39], v[38:39], v[54:55]
  v_pk_add_f32 v[40:41], v[40:41], v[56:57]
  v_pk_add_f32 v[42:43], v[42:43], v[58:59]
  v_pk_add_f32 v[44:45], v[44:45], v[60:61]
  v_pk_add_f32 v[46:47], v[46:47], v[62:63]
  s_waitcnt lgkmcnt(5)
  v_pk_add_f32 v[32:33], v[32:33], v[104:105]
  v_pk_add_f32 v[34:35], v[34:35], v[106:107]
  ds_read_b128 v[104:107], v26 offset:2048
  s_waitcnt lgkmcnt(5)
  v_pk_add_f32 v[36:37], v[36:37], v[108:109]
  v_pk_add_f32 v[38:39], v[38:39], v[110:111]
  ds_read_b128 v[108:111], v26 offset:3072
  s_waitcnt lgkmcnt(5)
  v_pk_add_f32 v[40:41], v[40:41], v[112:113]
  v_pk_add_f32 v[42:43], v[42:43], v[114:115]
  ds_read_b128 v[112:115], v27 offset:0
  s_waitcnt lgkmcnt(5)
  v_pk_add_f32 v[44:45], v[44:45], v[116:117]
  v_pk_add_f32 v[46:47], v[46:47], v[118:119]
  ds_read_b128 v[116:119], v27 offset:1024
  s_waitcnt lgkmcnt(5)
  v_pk_add_f32 v[32:33], v[32:33], v[120:121]
  v_pk_add_f32 v[34:35], v[34:35], v[122:123]
  ds_read_b128 v[120:123], v27 offset:2048
  s_waitcnt lgkmcnt(5)
  v_pk_add_f32 v[36:37], v[36:37], v[124:125]
  v_pk_add_f32 v[38:39], v[38:39], v[126:127]
  ds_read_b128 v[124:127], v27 offset:3072
  s_waitcnt lgkmcnt(5)
  v_pk_add_f32 v[40:41], v[40:41], v[104:105]
  v_pk_add_f32 v[42:43], v[42:43], v[106:107]
  s_waitcnt lgkmcnt(4)
  v_pk_add_f32 v[44:45], v[44:45], v[108:109]
  v_pk_add_f32 v[46:47], v[46:47], v[110:111]
  s_waitcnt lgkmcnt(3)
  v_pk_add_f32 v[32:33], v[32:33], v[112:113]
  v_pk_add_f32 v[34:35], v[34:35], v[114:115]
  s_waitcnt lgkmcnt(2)
  v_pk_add_f32 v[36:37], v[36:37], v[116:117]
  v_pk_add_f32 v[38:39], v[38:39], v[118:119]
  s_waitcnt lgkmcnt(1)
  v_pk_add_f32 v[40:41], v[40:41], v[120:121]
  v_pk_add_f32 v[42:43], v[42:43], v[122:123]
  s_waitcnt lgkmcnt(0)
  v_pk_add_f32 v[44:45], v[44:45], v[124:125]
  v_pk_add_f32 v[46:47], v[46:47], v[126:127]
  v_cvt_pk_bf16_f32 v96, v32, v33
  v_cvt_pk_bf16_f32 v97, v34, v35
  v_cvt_pk_bf16_f32 v98, v36, v37
  v_cvt_pk_bf16_f32 v99, v38, v39
  v_cvt_pk_bf16_f32 v100, v40, v41
  v_cvt_pk_bf16_f32 v101, v42, v43
  v_cvt_pk_bf16_f32 v102, v44, v45
  v_cvt_pk_bf16_f32 v103, v46, v47
  s_cmp_eq_u32 s13, 1
  s_nop 0
  s_cbranch_scc1 Lp4f_56
  s_mov_b32 s28, 0xe00000
  s_mov_b32 s29, 0x1280000
  s_lshl_b32 s23, s16, 1
  s_lshr_b32 s24, s12, 1
  s_add_u32 s23, s23, s24
  s_lshl_b32 s24, s17, 1
  s_and_b32 s25, s12, 1
  s_add_u32 s24, s24, s25
  s_lshl_b32 s25, s23, 15
  s_add_u32 s25, s25, s28
  s_lshl_b32 s26, s24, 11
  s_add_u32 s25, s25, s26
  buffer_store_dwordx4 v[96:99], v2, s[4:7], s25 offen sc1
  buffer_store_dwordx4 v[100:103], v2, s[4:7], s25 offen offset:1024 sc1
  v_pk_mul_f32 v[106:107], v[32:33], v[32:33]
  v_pk_add_f32 v[104:105], v[32:33], v[34:35]
  v_pk_fma_f32 v[106:107], v[34:35], v[34:35], v[106:107]
  v_pk_add_f32 v[104:105], v[104:105], v[36:37]
  v_pk_fma_f32 v[106:107], v[36:37], v[36:37], v[106:107]
  v_pk_add_f32 v[104:105], v[104:105], v[38:39]
  v_pk_fma_f32 v[106:107], v[38:39], v[38:39], v[106:107]
  v_pk_add_f32 v[104:105], v[104:105], v[40:41]
  v_pk_fma_f32 v[106:107], v[40:41], v[40:41], v[106:107]
  v_pk_add_f32 v[104:105], v[104:105], v[42:43]
  v_pk_fma_f32 v[106:107], v[42:43], v[42:43], v[106:107]
  v_pk_add_f32 v[104:105], v[104:105], v[44:45]
  v_pk_fma_f32 v[106:107], v[44:45], v[44:45], v[106:107]
  v_pk_add_f32 v[104:105], v[104:105], v[46:47]
  v_pk_fma_f32 v[106:107], v[46:47], v[46:47], v[106:107]
  v_add_f32 v104, v104, v105
  v_add_f32 v105, v106, v107
  v_mov_b32 v106, v104
  v_mov_b32 v107, v105
  s_nop 0
  v_permlane32_swap_b32 v104, v106
  v_permlane32_swap_b32 v105, v107
  v_pk_add_f32 v[104:105], v[104:105], v[106:107]
  s_lshl_b32 s25, s23, 12
  s_add_u32 s25, s25, s29
  s_lshl_b32 s26, s24, 8
  s_add_u32 s25, s25, s26
  v_lshlrev_b32 v13, 3, v1
  s_mov_b32 exec_hi, 0
  buffer_store_dwordx2 v[104:105], v13, s[4:7], s25 offen sc1
  s_mov_b64 exec, -1
  s_branch Lp4e_57
Lp4f_56:
  s_mov_b32 s8, s56
  s_mov_b32 s9, s57
  s_mov_b32 s10, 0x200000
  s_mov_b32 s11, 0x20000
  s_lshl_b32 s23, s16, 1
  s_lshr_b32 s24, s12, 1
  s_add_u32 s23, s23, s24
  s_lshl_b32 s24, s17, 1
  s_and_b32 s25, s12, 1
  s_add_u32 s24, s24, s25
  v_permlane32_swap_b32 v96, v98
  v_permlane32_swap_b32 v97, v99
  v_permlane32_swap_b32 v100, v102
  v_permlane32_swap_b32 v101, v103
  v_and_b32 v13, 31, v1
  v_lshlrev_b32 v13, 10, v13
  v_lshrrev_b32 v14, 5, v1
  v_lshl_add_u32 v13, v14, 4, v13
  s_lshl_b32 s25, s23, 15
  s_lshl_b32 s26, s24, 6
  s_add_u32 s25, s25, s26
  buffer_store_dwordx4 v[96:99], v13, s[8:11], s25 offen
  buffer_store_dwordx4 v[100:103], v13, s[8:11], s25 offen offset:32
  s_nop 1
Lp4e_57:
  s_cmp_eq_u32 s13, 1
  s_cbranch_scc1 L_fin
  s_cmp_eq_u32 s12, 0
  s_cbranch_scc1 Lw_58
  s_mul_i32 s20, s15, 101376
  s_add_u32 s20, s20, 1048576
  s_sub_u32 s21, s12, 1
  s_mul_i32 s21, s21, 2
  s_add_u32 s21, s21, 0
  s_min_u32 s21, s21, 4
  s_add_u32 s22, s21, 0
  s_lshr_b32 s23, s22, 3
  s_mul_i32 s23, s23, 33792
  s_and_b32 s24, s22, 7
  s_lshl_b32 s24, s24, 12
  s_add_u32 s23, s23, s24
  s_add_u32 s23, s23, s20
  s_lshl_b32 s24, s22, 12
  s_add_u32 m0, s24, 0
  s_nop 0
  buffer_load_dwordx4 v2, s[4:7], s23 offen offset:0 sc1 lds
  buffer_load_dwordx4 v2, s[4:7], s23 offen offset:1024 sc1 lds
  buffer_load_dwordx4 v2, s[4:7], s23 offen offset:2048 sc1 lds
  buffer_load_dwordx4 v2, s[4:7], s23 offen offset:3072 sc1 lds
  s_add_u32 s22, s21, 1
  s_lshr_b32 s23, s22, 3
  s_mul_i32 s23, s23, 33792
  s_and_b32 s24, s22, 7
  s_lshl_b32 s24, s24, 12
  s_add_u32 s23, s23, s24
  s_add_u32 s23, s23, s20
  s_lshl_b32 s24, s22, 12
  s_add_u32 m0, s24, 0
  s_nop 0
  buffer_load_dwordx4 v2, s[4:7], s23 offen offset:0 sc1 lds
  buffer_load_dwordx4 v2, s[4:7], s23 offen offset:1024 sc1 lds
  buffer_load_dwordx4 v2, s[4:7], s23 offen offset:2048 sc1 lds
  buffer_load_dwordx4 v2, s[4:7], s23 offen offset:3072 sc1 lds
  s_waitcnt vmcnt(8)
Lw_58:
  s_cmp_lg_u32 s12, 0
  s_cbranch_scc1 Lw_59
  s_waitcnt vmcnt(0)
Lw_59:
  s_barrier
  s_cmp_lg_u32 s12, 0
  s_cbranch_scc1 Lw_60
  s_lshl_b32 s39, s13, 3
  s_add_u32 s39, s39, 8
  s_lshl_b32 s38, s2, 7
  v_mov_b32 v214, s38
  v_mov_b32 v215, s39
  s_mov_b64 exec, 1
  buffer_store_dword v215, v214, s[4:7], 0 offen offset:0 sc1
  s_mov_b64 exec, -1
Lw_60:
  s_cmp_eq_u32 s12, 0
  s_cbranch_scc1 Lw_61
  s_mul_i32 s20, s15, 101376
  s_add_u32 s20, s20, 1048576
  s_sub_u32 s21, s12, 1
  s_mul_i32 s21, s21, 6
  s_add_u32 s21, s21, 6
  s_min_u32 s21, s21, 18
  s_add_u32 s22, s21, 0
  s_lshr_b32 s23, s22, 3
  s_mul_i32 s23, s23, 33792
  s_and_b32 s24, s22, 7
  s_lshl_b32 s24, s24, 12
  s_add_u32 s23, s23, s24
  s_add_u32 s23, s23, s20
  s_lshl_b32 s24, s22, 12
  s_add_u32 m0, s24, 0
  s_nop 0
  buffer_load_dwordx4 v2, s[4:7], s23 offen offset:0 sc1 lds
  buffer_load_dwordx4 v2, s[4:7], s23 offen offset:1024 sc1 lds
  buffer_load_dwordx4 v2, s[4:7], s23 offen offset:2048 sc1 lds
  buffer_load_dwordx4 v2, s[4:7], s23 offen offset:3072 sc1 lds
  s_add_u32 s22, s21, 1
  s_lshr_b32 s23, s22, 3
  s_mul_i32 s23, s23, 33792
  s_and_b32 s24, s22, 7
  s_lshl_b32 s24, s24, 12
  s_add_u32 s23, s23, s24
  s_add_u32 s23, s23, s20
  s_lshl_b32 s24, s22, 12
  s_add_u32 m0, s24, 0
  s_nop 0
  buffer_load_dwordx4 v2, s[4:7], s23 offen offset:0 sc1 lds
  buffer_load_dwordx4 v2, s[4:7], s23 offen offset:1024 sc1 lds
  buffer_load_dwordx4 v2, s[4:7], s23 offen offset:2048 sc1 lds
  buffer_load_dwordx4 v2, s[4:7], s23 offen offset:3072 sc1 lds
  s_add_u32 s22, s21, 2
  s_lshr_b32 s23, s22, 3
  s_mul_i32 s23, s23, 33792
  s_and_b32 s24, s22, 7
  s_lshl_b32 s24, s24, 12
  s_add_u32 s23, s23, s24
  s_add_u32 s23, s23, s20
  s_lshl_b32 s24, s22, 12
  s_add_u32 m0, s24, 0
  s_nop 0
  buffer_load_dwordx4 v2, s[4:7], s23 offen offset:0 sc1 lds
  buffer_load_dwordx4 v2, s[4:7], s23 offen offset:1024 sc1 lds
  buffer_load_dwordx4 v2, s[4:7], s23 offen offset:2048 sc1 lds
  buffer_load_dwordx4 v2, s[4:7], s23 offen offset:3072 sc1 lds
  s_add_u32 s22, s21, 3
  s_lshr_b32 s23, s22, 3
  s_mul_i32 s23, s23, 33792
  s_and_b32 s24, s22, 7
  s_lshl_b32 s24, s24, 12
  s_add_u32 s23, s23, s24
  s_add_u32 s23, s23, s20
  s_lshl_b32 s24, s22, 12
  s_add_u32 m0, s24, 0
  s_nop 0
  buffer_load_dwordx4 v2, s[4:7], s23 offen offset:0 sc1 lds
  buffer_load_dwordx4 v2, s[4:7], s23 offen offset:1024 sc1 lds
  buffer_load_dwordx4 v2, s[4:7], s23 offen offset:2048 sc1 lds
  buffer_load_dwordx4 v2, s[4:7], s23 offen offset:3072 sc1 lds
  s_add_u32 s22, s21, 4
  s_lshr_b32 s23, s22, 3
  s_mul_i32 s23, s23, 33792
  s_and_b32 s24, s22, 7
  s_lshl_b32 s24, s24, 12
  s_add_u32 s23, s23, s24
  s_add_u32 s23, s23, s20
  s_lshl_b32 s24, s22, 12
  s_add_u32 m0, s24, 0
  s_nop 0
  buffer_load_dwordx4 v2, s[4:7], s23 offen offset:0 sc1 lds
  buffer_load_dwordx4 v2, s[4:7], s23 offen offset:1024 sc1 lds
  buffer_load_dwordx4 v2, s[4:7], s23 offen offset:2048 sc1 lds
  buffer_load_dwordx4 v2, s[4:7], s23 offen offset:3072 sc1 lds
  s_add_u32 s22, s21, 5
  s_lshr_b32 s23, s22, 3
  s_mul_i32 s23, s23, 33792
  s_and_b32 s24, s22, 7
  s_lshl_b32 s24, s24, 12
  s_add_u32 s23, s23, s24
  s_add_u32 s23, s23, s20
  s_lshl_b32 s24, s22, 12
  s_add_u32 m0, s24, 0
  s_nop 0
  buffer_load_dwordx4 v2, s[4:7], s23 offen offset:0 sc1 lds
  buffer_load_dwordx4 v2, s[4:7], s23 offen offset:1024 sc1 lds
  buffer_load_dwordx4 v2, s[4:7], s23 offen offset:2048 sc1 lds
  buffer_load_dwordx4 v2, s[4:7], s23 offen offset:3072 sc1 lds
Lw_61:
  s_mov_b32 s13, 1
  s_branch L_layer
L_fin:
  s_waitcnt vmcnt(0)
  s_waitcnt vmcnt(0) lgkmcnt(0)
L_end:
  s_endpgm
.section .rodata,"a"
.p2align 6
.amdhsa_kernel interleave_layers__linear_kernel_hedgehog__glu_gated_swiglu__prompt_kernel
  .amdhsa_next_free_vgpr 512
  .amdhsa_next_free_sgpr 102
  .amdhsa_accum_offset 256
  .amdhsa_group_segment_fixed_size 0
  .amdhsa_kernarg_size 88
  .amdhsa_user_sgpr_count 2
  .amdhsa_user_sgpr_kernarg_segment_ptr 1
  .amdhsa_system_sgpr_workgroup_id_x 1
.end_amdhsa_kernel
```
